```python
import torch

def _softmax(x, axis=-1):
    return torch.softmax(x, dim=axis)
def _gelu(x):
    return torch.nn.functional.gelu(x, approximate="tanh")
def _silu(x):
    return torch.nn.functional.silu(x)
def _sigmoid(x):
    return torch.sigmoid(x)
def _layernorm(x, axis=-1, eps=1e-5):
    m = x.mean(dim=axis, keepdim=True)
    v = x.var(dim=axis, keepdim=True, unbiased=False)
    return (x - m) / torch.sqrt(v + eps)
def _scatter_add(tgt, idx, src, axis=0):
    return tgt.clone().index_add_(axis, idx, src)
def _segment_sum(src, seg, n):
    out = torch.zeros((n,) + src.shape[1:], dtype=src.dtype)
    return out.index_add_(0, seg, src)
def _pad(x, pw):
    flat = tuple(v for pair in reversed(pw) for v in pair)
    return torch.nn.functional.pad(x, flat)

kernel_name = 'parallel_sum__linear_kernel_hedgehog__dense_activation_mish__prompt'

def setup_inputs():

    _w = (lambda a: (lambda t: t.to(torch.bfloat16) if t.is_floating_point() else t)(torch.as_tensor(a)))
    def _A_setup():
        B, S, D, H = 1, 2048, 512, 32
        Dh = D // H
        return {
            "x": _w((lambda *s: torch.randn(*s, dtype=torch.bfloat16) * 0.05)(B, S, D)),
            "wqkv": _w((lambda *s: torch.randn(*s, dtype=torch.bfloat16) * 0.2)(D, 3 * D)),
            "w_phi": _w((lambda *s: torch.randn(*s, dtype=torch.bfloat16) * 0.2)(H, Dh, Dh) * (Dh ** -0.5)),
            "wo": _w((lambda *s: torch.randn(*s, dtype=torch.bfloat16) * 0.05)(D, D)),
        }
    _A_in = _A_setup()

    def _B_setup():
        B, S, D, F = 1, 2048, 512, 1376
        return {
            "x": _w((lambda *s: torch.randn(*s, dtype=torch.bfloat16) * 0.05)(B, S, D)),
            "w1": _w((lambda *s: torch.randn(*s, dtype=torch.bfloat16) * 0.8)(D, F) * (D ** -0.5)),
            "b1": _w((lambda *s: torch.randn(*s, dtype=torch.bfloat16) * 0.2)(F)),
            "w2": _w((lambda *s: torch.randn(*s, dtype=torch.bfloat16) * 0.1)(F, D) * (F ** -0.5)),
        }
    _B_in = _B_setup()

    return {
        "A_x": _A_in["x"],
        "A_wqkv": _A_in["wqkv"],
        "A_w_phi": _A_in["w_phi"],
        "A_wo": _A_in["wo"],
        "B_x": _B_in["x"],
        "B_w1": _B_in["w1"],
        "B_b1": _B_in["b1"],
        "B_w2": _B_in["w2"],
    }

def reference(A_x, A_wqkv, A_w_phi, A_wo, B_x, B_w1, B_b1, B_w2):
    def _A_ref(x, wqkv, w_phi, wo):
        B, S, D = x.shape
        H = 32; Dh = D // H
        qkv = (lambda x, *d: x.permute(*d))((x @ wqkv).reshape(B, S, 3, H, Dh), 2, 0, 3, 1, 4)
        q, k, v = qkv[0], qkv[1], qkv[2]
        pq = torch.einsum("bhsd,hdf->bhsf", q, w_phi)
        pk = torch.einsum("bhsd,hdf->bhsf", k, w_phi)
        phi_q = torch.concatenate([_softmax(pq, axis=-1), _softmax(-pq, axis=-1)], axis=-1)
        phi_k = torch.concatenate([_softmax(pk, axis=-1), _softmax(-pk, axis=-1)], axis=-1)
        kv = torch.einsum("bhsf,bhsd->bhfd", phi_k, v)
        z  = torch.einsum("bhsf->bhf", phi_k)
        num = torch.einsum("bhqf,bhfd->bhqd", phi_q, kv)
        den = torch.einsum("bhqf,bhf->bhq", phi_q, z)[..., None] + 1e-6
        o = num / den
        return (lambda x, *d: x.permute(*d))(o, 0, 2, 1, 3).reshape(B, S, D) @ wo

    def _B_ref(x, w1, b1, w2):
        h = torch.einsum("bsd,df->bsf", x, w1) + b1
        sp = torch.log1p(torch.exp(-torch.abs(h))) + torch.where(h > 0, h, torch.zeros_like(h))
        act = h * torch.tanh(sp)
        return torch.einsum("bsf,fd->bsd", act, w2)

    x = A_x
    xn = _layernorm(x, axis=-1)
    return x + _A_ref(xn, A_wqkv, A_w_phi, A_wo) + _B_ref(xn, B_w1, B_b1, B_w2)
```

```asm
; @launch grid=(256,1,1) block=(512,1,1) lds=163840
.amdgcn_target "amdgcn-amd-amdhsa--gfx950"
.text
.globl parallel_sum__linear_kernel_hedgehog__dense_activation_mish__prompt_kernel
.p2align 8
.type parallel_sum__linear_kernel_hedgehog__dense_activation_mish__prompt_kernel,@function
parallel_sum__linear_kernel_hedgehog__dense_activation_mish__prompt_kernel:
    s_cmp_ge_u32 s2, 256
    s_cbranch_scc1 L_END
    s_load_dwordx16 s[16:31], s[0:1], 0
    s_load_dwordx4 s[32:35], s[0:1], 64
    s_load_dwordx2 s[36:37], s[0:1], 80
    s_memrealtime s[6:7]
    v_and_b32 v255, 63, v0
    v_lshrrev_b32 v236, 6, v0
    v_lshlrev_b32 v254, 4, v255
    v_readfirstlane_b32 s4, v236
    s_and_b32 s14, s2, 7
    s_lshr_b32 s15, s2, 3
    s_and_b32 s5, s14, 1
    s_lshl_b32 s5, s5, 3
    s_and_b32 s76, s15, 7
    s_add_u32 s5, s5, s76
    s_lshr_b32 s8, s14, 1
    s_lshl_b32 s8, s8, 2
    s_lshr_b32 s76, s15, 3
    s_add_u32 s8, s8, s76
    s_and_b32 s9, s8, 1
    s_lshr_b32 s10, s8, 1
    s_xor_b32 s39, s10, 2
    s_cmp_eq_u32 s9, 1
    s_cselect_b32 s39, s10, s39
    s_lshl_b32 s11, s8, 1
    s_add_u32 s11, s11, s5
    s_and_b32 s11, s11, 7
    s_lshr_b32 s12, s14, 1
    s_andn2_b32 s76, 1, s14
    s_lshl_b32 s76, s76, 2
    s_add_u32 s12, s12, s76
    s_lshl_b32 s12, s12, 2
    s_and_b32 s76, s15, 3
    s_add_u32 s12, s12, s76
    s_lshr_b32 s13, s15, 2
    s_xor_b32 s76, s12, s13
    s_and_b32 s76, s76, 4
    s_xor_b32 s12, s12, s76
    s_xor_b32 s13, s13, s76
    s_and_b32 s84, s4, 3
    s_mov_b32 s38, 0
    s_cmp_ge_u32 s4, 4
    s_cbranch_scc1 C_START
    s_lshl_b32 s14, s10, 7
    s_lshl_b32 s15, s10, 8
    s_add_u32 s68, s14, 1024
    s_add_u32 s69, s14, 2048
    s_add_u32 s77, s15, 128
    s_lshl_b32 s76, s39, 7
    s_cmp_eq_u32 s9, 1
    s_cselect_b32 s70, s69, s76
    s_cselect_b32 s68, s68, s15
    s_cselect_b32 s69, s69, s77
    s_movk_i32 s15, 2752
    s_cselect_b32 s76, 3072, s15
    s_cselect_b32 s77, s15, 3072
    v_lshrrev_b32 v236, 3, v255
    v_lshrrev_b32 v237, 2, v255
    v_and_b32 v237, 4, v237
    v_and_b32 v238, 7, v255
    v_xor_b32 v237, v237, v238
    v_lshlrev_b32 v237, 4, v237
    s_lshl_b32 s14, s13, 7
    v_lshl_add_u32 v252, v236, 10, v237
    v_add_u32 v252, s14, v252
    v_mul_u32_u24 v227, s76, v236
    v_add3_u32 v226, v227, v237, s68
    v_add3_u32 v227, v227, v237, s69
    v_add_u32 v239, s70, v237
    v_mul_u32_u24 v228, s77, v236
    v_add_u32 v228, v228, v239
    v_cmp_gt_u32 vcc, 2752, v239
    v_mov_b32 v239, 0x7f000000
    s_nop 0
    v_cndmask_b32 v228, v239, v228, vcc
    s_lshl_b32 s52, s76, 4
    s_lshl_b32 s53, s76, 3
    s_sub_u32 s53, s53, 1024
    s_lshl_b32 s54, s77, 4
    s_lshl_b32 s55, s77, 3
    s_sub_u32 s55, s55, 1024
    v_lshrrev_b32 v237, 4, v255
    v_xor_b32 v237, v237, v238
    s_lshl_b32 s14, s5, 2
    s_add_u32 s14, s14, s84
    s_lshl_b32 s14, s14, 15
    v_lshlrev_b32 v224, 10, v236
    v_lshl_add_u32 v224, v237, 4, v224
    v_add_u32 v224, s14, v224
    v_xor_b32 v225, 64, v224
    s_lshl_b32 s85, s84, 11
    s_lshl_b32 s86, s5, 4
    s_add_u32 s86, s86, s8
    s_lshl_b32 s86, s86, 2
    s_add_u32 s86, s86, s84
    s_lshl_b32 s87, s86, 11
    v_and_b32 v240, 32, v255
    v_lshl_add_u32 v240, v240, 4, v254
    v_mov_b32 v241, 0
    s_or_b32 s14, s2, s4
    s_waitcnt lgkmcnt(0)
    s_mov_b32 s60, s34
    s_mov_b32 s61, s35
    s_mov_b32 s62, 0x100
    s_mov_b32 s63, 0x20000
    s_cmp_lg_u32 s14, 0
    s_cbranch_scc1 L_NONONCE
    s_or_b32 s6, s6, 1
    v_mov_b32 v236, s6
    buffer_store_dword v236, v241, s[60:63], 0 offen offset:128 sc1
    s_nop 1
L_NONONCE:
    s_mov_b32 s40, s16
    s_mov_b32 s41, s17
    s_mov_b32 s42, 0x200000
    s_mov_b32 s43, 0x20000
    s_cmp_eq_u32 s9, 1
    s_cselect_b32 s44, s18, s26
    s_cselect_b32 s45, s19, s27
    s_mov_b32 s47, 0x20000
    s_cselect_b32 s48, s26, s18
    s_cselect_b32 s49, s27, s19
    s_mov_b32 s51, 0x20000
    s_lshl_b32 s46, s52, 5
    s_lshl_b32 s50, s54, 5
    buffer_load_dwordx4 v[0:3], v240, s[40:43], s87 offen
    buffer_load_dwordx4 v[4:7], v240, s[40:43], s87 offen offset:512
    s_add_u32 s77, s11, 0
    s_and_b32 s77, s77, 7
    s_lshl_b32 s77, s77, 2
    s_add_u32 s77, s77, s84
    s_mul_i32 s78, s77, s52
    s_add_u32 m0, s85, 65536
    s_add_u32 s79, s78, s53
    buffer_load_dwordx4 v226, s[44:47], s78 offen lds
    buffer_load_dwordx4 v226, s[44:47], s79 offen offset:1024 lds
    s_add_u32 m0, s85, 73728
    s_nop 0
    buffer_load_dwordx4 v227, s[44:47], s78 offen lds
    buffer_load_dwordx4 v227, s[44:47], s79 offen offset:1024 lds
    s_add_u32 s77, s11, 0
    s_and_b32 s77, s77, 7
    s_lshl_b32 s78, s77, 7
    s_lshl_b32 m0, s84, 12
    s_nop 0
    buffer_load_dwordx4 v224, s[40:43], s78 offen offset:0 lds
    s_add_u32 s79, s78, 7168
    buffer_load_dwordx4 v225, s[40:43], s79 offen offset:1024 lds
    s_add_u32 s80, s78, 14336
    buffer_load_dwordx4 v224, s[40:43], s80 offen offset:2048 lds
    s_add_u32 s81, s78, 21504
    buffer_load_dwordx4 v225, s[40:43], s81 offen offset:3072 lds
    s_add_u32 s77, s11, 0
    s_and_b32 s77, s77, 7
    s_lshl_b32 s77, s77, 2
    s_add_u32 s77, s77, s84
    s_mul_i32 s78, s77, s54
    s_add_u32 m0, s85, 139264
    s_add_u32 s79, s78, s55
    buffer_load_dwordx4 v228, s[48:51], s78 offen lds
    buffer_load_dwordx4 v228, s[48:51], s79 offen offset:1024 lds
    buffer_load_dword v230, v241, s[60:63], 0 offen offset:128 sc1
    s_add_u32 s77, s11, 1
    s_and_b32 s77, s77, 7
    s_lshl_b32 s77, s77, 2
    s_add_u32 s77, s77, s84
    s_mul_i32 s78, s77, s52
    s_add_u32 m0, s85, 81920
    s_add_u32 s79, s78, s53
    buffer_load_dwordx4 v226, s[44:47], s78 offen lds
    buffer_load_dwordx4 v226, s[44:47], s79 offen offset:1024 lds
    s_add_u32 m0, s85, 90112
    s_nop 0
    buffer_load_dwordx4 v227, s[44:47], s78 offen lds
    buffer_load_dwordx4 v227, s[44:47], s79 offen offset:1024 lds
    s_add_u32 s77, s11, 1
    s_and_b32 s77, s77, 7
    s_lshl_b32 s78, s77, 7
    s_lshl_b32 m0, s84, 12
    s_add_u32 m0, m0, 16384
    s_nop 0
    buffer_load_dwordx4 v224, s[40:43], s78 offen offset:0 lds
    s_add_u32 s79, s78, 7168
    buffer_load_dwordx4 v225, s[40:43], s79 offen offset:1024 lds
    s_add_u32 s80, s78, 14336
    buffer_load_dwordx4 v224, s[40:43], s80 offen offset:2048 lds
    s_add_u32 s81, s78, 21504
    buffer_load_dwordx4 v225, s[40:43], s81 offen offset:3072 lds
    buffer_load_dword v231, v241, s[60:63], 0 offen offset:128 sc1
    s_mov_b32 s56, s36
    s_mov_b32 s57, s37
    s_mov_b32 s58, 0xe00000
    s_mov_b32 s59, 0x20000
    s_lshl_b32 s7, s86, 4
    s_add_u32 s7, s7, 0xc80000
    s_mov_b32 s64, s30
    s_mov_b32 s65, s31
    s_mov_b32 s66, 0x158000
    s_mov_b32 s67, 0x20000
    v_lshrrev_b32 v236, 5, v255
    v_bfe_u32 v237, v255, 2, 2
    v_mul_u32_u24 v236, 8, v236
    v_add_lshl_u32 v234, v236, v237, 7
    v_bfe_u32 v236, v255, 3, 1
    v_xor_b32 v236, s84, v236
    v_lshl_add_u32 v234, v236, 6, v234
    v_bfe_u32 v236, v255, 4, 1
    v_lshl_add_u32 v234, v236, 5, v234
    v_and_b32 v236, 3, v255
    v_lshl_add_u32 v234, v236, 3, v234
    s_lshr_b32 s14, s5, 3
    s_lshl_b32 s14, s14, 12
    s_add_u32 s14, s14, 65536
    v_add_u32 v234, s14, v234
    v_add_u32 v235, 73728, v234
    v_lshrrev_b32 v236, 2, v255
    v_xor_b32 v236, v236, v255
    v_and_b32 v236, 4, v236
    v_cmp_eq_u32 vcc, 0, v236
    v_mov_b32 v237, 0x3f803f80
    s_nop 0
    v_cndmask_b32 v68, 0, v237, vcc
    v_mov_b32 v69, v68
    v_mov_b32 v70, v68
    v_mov_b32 v71, v68
    v_lshlrev_b32 v253, 2, v255
    v_and_b32 v253, 0x7c, v253
    s_waitcnt vmcnt(20)
    v_lshlrev_b32 v8, 16, v0
    v_and_b32 v9, 0xffff0000, v0
    v_lshlrev_b32 v10, 16, v1
    v_and_b32 v11, 0xffff0000, v1
    v_lshlrev_b32 v12, 16, v2
    v_and_b32 v13, 0xffff0000, v2
    v_lshlrev_b32 v14, 16, v3
    v_and_b32 v15, 0xffff0000, v3
    v_lshlrev_b32 v16, 16, v4
    v_and_b32 v17, 0xffff0000, v4
    v_lshlrev_b32 v18, 16, v5
    v_and_b32 v19, 0xffff0000, v5
    v_lshlrev_b32 v20, 16, v6
    v_and_b32 v21, 0xffff0000, v6
    v_lshlrev_b32 v22, 16, v7
    v_and_b32 v23, 0xffff0000, v7
    v_add_f32 v0, v8, v12
    v_add_f32 v4, v16, v20
    v_add_f32 v1, v9, v13
    v_add_f32 v5, v17, v21
    v_add_f32 v2, v10, v14
    v_add_f32 v6, v18, v22
    v_add_f32 v3, v11, v15
    v_add_f32 v7, v19, v23
    v_add_f32 v0, v0, v4
    v_add_f32 v1, v1, v5
    v_add_f32 v2, v2, v6
    v_add_f32 v3, v3, v7
    v_add_f32 v0, v0, v2
    v_add_f32 v1, v1, v3
    v_add_f32 v0, v0, v1
    s_nop 1
    v_add_f32_dpp v0, v0, v0 quad_perm:[1,0,3,2] row_mask:0xf bank_mask:0xf
    s_nop 1
    v_add_f32_dpp v0, v0, v0 quad_perm:[2,3,0,1] row_mask:0xf bank_mask:0xf
    s_nop 1
    v_add_f32_dpp v0, v0, v0 row_half_mirror row_mask:0xf bank_mask:0xf
    s_nop 1
    v_add_f32_dpp v0, v0, v0 row_mirror row_mask:0xf bank_mask:0xf
    v_mov_b32 v1, v0
    s_nop 1
    v_permlane16_swap_b32 v0, v1
    v_add_f32 v0, v0, v1
    v_mul_f32 v0, 0xbb000000, v0
    v_add_f32 v8, v8, v0
    v_add_f32 v9, v9, v0
    v_add_f32 v10, v10, v0
    v_add_f32 v11, v11, v0
    v_add_f32 v12, v12, v0
    v_add_f32 v13, v13, v0
    v_add_f32 v14, v14, v0
    v_add_f32 v15, v15, v0
    v_add_f32 v16, v16, v0
    v_add_f32 v17, v17, v0
    v_add_f32 v18, v18, v0
    v_add_f32 v19, v19, v0
    v_add_f32 v20, v20, v0
    v_add_f32 v21, v21, v0
    v_add_f32 v22, v22, v0
    v_add_f32 v23, v23, v0
    v_mul_f32 v4, v8, v8
    v_mul_f32 v5, v9, v9
    v_mul_f32 v6, v10, v10
    v_mul_f32 v7, v11, v11
    v_fmac_f32 v4, v12, v12
    v_fmac_f32 v5, v13, v13
    v_fmac_f32 v6, v14, v14
    v_fmac_f32 v7, v15, v15
    v_fmac_f32 v4, v16, v16
    v_fmac_f32 v5, v17, v17
    v_fmac_f32 v6, v18, v18
    v_fmac_f32 v7, v19, v19
    v_fmac_f32 v4, v20, v20
    v_fmac_f32 v5, v21, v21
    v_fmac_f32 v6, v22, v22
    v_fmac_f32 v7, v23, v23
    v_add_f32 v4, v4, v5
    v_add_f32 v6, v6, v7
    v_add_f32 v4, v4, v6
    s_nop 1
    v_add_f32_dpp v4, v4, v4 quad_perm:[1,0,3,2] row_mask:0xf bank_mask:0xf
    s_nop 1
    v_add_f32_dpp v4, v4, v4 quad_perm:[2,3,0,1] row_mask:0xf bank_mask:0xf
    s_nop 1
    v_add_f32_dpp v4, v4, v4 row_half_mirror row_mask:0xf bank_mask:0xf
    s_nop 1
    v_add_f32_dpp v4, v4, v4 row_mirror row_mask:0xf bank_mask:0xf
    v_mov_b32 v5, v4
    s_nop 1
    v_permlane16_swap_b32 v4, v5
    v_add_f32 v4, v4, v5
    v_mul_f32 v4, 0x3b000000, v4
    v_cvt_pk_bf16_f32 v4, v4, v4
    v_lshlrev_b32 v4, 16, v4
    v_add_f32 v4, 0x3727c5ac, v4
    v_cvt_pk_bf16_f32 v4, v4, v4
    v_lshlrev_b32 v4, 16, v4
    v_sqrt_f32 v4, v4
    s_nop 0
    v_cvt_pk_bf16_f32 v232, v0, v4
    v_cmp_eq_u32 vcc, 0, v253
    v_lshrrev_b32 v236, 2, v255
    v_mov_b32 v237, 0x7f000000
    v_cndmask_b32 v240, v237, v236, vcc
    s_add_u32 s77, s11, 2
    s_and_b32 s77, s77, 7
    s_lshl_b32 s77, s77, 2
    s_add_u32 s77, s77, s84
    s_mul_i32 s78, s77, s52
    s_add_u32 m0, s85, 98304
    s_add_u32 s79, s78, s53
    buffer_load_dwordx4 v226, s[44:47], s78 offen lds
    buffer_load_dwordx4 v226, s[44:47], s79 offen offset:1024 lds
    s_add_u32 m0, s85, 106496
    s_nop 0
    buffer_load_dwordx4 v227, s[44:47], s78 offen lds
    buffer_load_dwordx4 v227, s[44:47], s79 offen offset:1024 lds
    s_add_u32 s77, s11, 2
    s_and_b32 s77, s77, 7
    s_lshl_b32 s78, s77, 7
    s_lshl_b32 m0, s84, 12
    s_add_u32 m0, m0, 32768
    s_nop 0
    buffer_load_dwordx4 v224, s[40:43], s78 offen offset:0 lds
    s_add_u32 s79, s78, 7168
    buffer_load_dwordx4 v225, s[40:43], s79 offen offset:1024 lds
    s_add_u32 s80, s78, 14336
    buffer_load_dwordx4 v224, s[40:43], s80 offen offset:2048 lds
    s_add_u32 s81, s78, 21504
    buffer_load_dwordx4 v225, s[40:43], s81 offen offset:3072 lds
    s_waitcnt vmcnt(17)
    s_barrier
    s_cmp_ge_u32 s84, 2
    s_cbranch_scc1 L_NOCF
    ds_read_b64_tr_b16 v[32:33], v234 offset:0
    ds_read_b64_tr_b16 v[34:35], v234 offset:512
    ds_read_b64_tr_b16 v[36:37], v234 offset:8192
    ds_read_b64_tr_b16 v[38:39], v234 offset:8704
    ds_read_b64_tr_b16 v[40:41], v235 offset:0
    ds_read_b64_tr_b16 v[42:43], v235 offset:512
    ds_read_b64_tr_b16 v[44:45], v234 offset:2048
    ds_read_b64_tr_b16 v[46:47], v234 offset:2560
    ds_read_b64_tr_b16 v[48:49], v234 offset:10240
    ds_read_b64_tr_b16 v[50:51], v234 offset:10752
    ds_read_b64_tr_b16 v[52:53], v235 offset:2048
    ds_read_b64_tr_b16 v[54:55], v235 offset:2560
L_NOCF:
    v_readfirstlane_b32 s3, v230
    s_nop 1
    s_cmp_lg_u32 s3, 0
    s_nop 1
    s_cbranch_scc1 LN_DONE
    s_waitcnt vmcnt(8)
    v_mov_b32 v230, v231
    s_mov_b32 s14, 0
    s_nop 1
LN_P:
    v_cmp_eq_u32 vcc, 0, v230
    s_nop 1
    s_cmp_eq_u64 vcc, 0
    s_nop 1
    s_cbranch_scc1 LN_G
    s_add_u32 s14, s14, 1
    s_cmp_gt_u32 s14, 0x8000
    s_cbranch_scc1 LN_G
    s_sleep 8
    buffer_load_dword v230, v241, s[60:63], 0 offen offset:128 sc1
    s_waitcnt vmcnt(0)
    s_branch LN_P
LN_G:
    v_readfirstlane_b32 s3, v230
    s_nop 4
LN_DONE:
    v_mov_b32 v233, v230
    buffer_store_dwordx2 v[232:233], v240, s[56:59], s7 offen sc1
    s_cmp_ge_u32 s84, 2
    s_nop 0
    s_cbranch_scc1 LB_START
    s_lshl_b32 s6, s8, 1
    s_add_u32 s6, s6, s84
    s_lshl_b32 s6, s6, 13
    s_add_u32 s6, s6, 0xca0000
    s_lshl_b32 s15, s5, 9
    s_add_u32 s15, s15, s6
    v_and_b32 v236, 0x1ff, v254
    s_waitcnt lgkmcnt(0)
    v_mfma_f32_16x16x32_bf16 v[56:59], v[68:71], v[32:35], 0
    v_mfma_f32_16x16x32_bf16 v[60:63], v[68:71], v[36:39], 0
    v_mfma_f32_16x16x32_bf16 v[64:67], v[68:71], v[40:43], 0
    v_mfma_f32_16x16x32_bf16 v[56:59], v[68:71], v[44:47], v[56:59]
    v_mfma_f32_16x16x32_bf16 v[60:63], v[68:71], v[48:51], v[60:63]
    v_mfma_f32_16x16x32_bf16 v[64:67], v[68:71], v[52:55], v[64:67]
    s_nop 6
    v_mov_b32 v57, v60
    v_mov_b32 v58, v64
    v_mov_b32 v59, v230
    buffer_store_dwordx4 v[56:59], v236, s[56:59], s15 offen sc1
    s_add_u32 s7, s6, 4096
    s_add_u32 s77, s11, 3
    s_and_b32 s77, s77, 7
    s_lshl_b32 s77, s77, 2
    s_add_u32 s77, s77, s84
    s_mul_i32 s78, s77, s52
    s_add_u32 m0, s85, 114688
    s_add_u32 s79, s78, s53
    buffer_load_dwordx4 v226, s[44:47], s78 offen lds
    buffer_load_dwordx4 v226, s[44:47], s79 offen offset:1024 lds
    s_add_u32 m0, s85, 122880
    s_nop 0
    buffer_load_dwordx4 v227, s[44:47], s78 offen lds
    buffer_load_dwordx4 v227, s[44:47], s79 offen offset:1024 lds
    s_add_u32 s77, s11, 3
    s_and_b32 s77, s77, 7
    s_lshl_b32 s78, s77, 7
    s_lshl_b32 m0, s84, 12
    s_add_u32 m0, m0, 49152
    s_nop 0
    buffer_load_dwordx4 v224, s[40:43], s78 offen offset:0 lds
    s_add_u32 s79, s78, 7168
    buffer_load_dwordx4 v225, s[40:43], s79 offen offset:1024 lds
    s_add_u32 s80, s78, 14336
    buffer_load_dwordx4 v224, s[40:43], s80 offen offset:2048 lds
    s_add_u32 s81, s78, 21504
    buffer_load_dwordx4 v225, s[40:43], s81 offen offset:3072 lds
    s_waitcnt vmcnt(19)
    s_barrier
    s_add_u32 s77, s11, 4
    s_and_b32 s77, s77, 7
    s_lshl_b32 s77, s77, 2
    s_add_u32 s77, s77, s84
    s_mul_i32 s78, s77, s52
    s_add_u32 m0, s85, 65536
    s_add_u32 s79, s78, s53
    buffer_load_dwordx4 v226, s[44:47], s78 offen lds
    buffer_load_dwordx4 v226, s[44:47], s79 offen offset:1024 lds
    s_add_u32 m0, s85, 73728
    s_nop 0
    buffer_load_dwordx4 v227, s[44:47], s78 offen lds
    buffer_load_dwordx4 v227, s[44:47], s79 offen offset:1024 lds
    s_add_u32 s77, s11, 4
    s_and_b32 s77, s77, 7
    s_lshl_b32 s78, s77, 7
    s_lshl_b32 m0, s84, 12
    s_nop 0
    buffer_load_dwordx4 v224, s[40:43], s78 offen offset:0 lds
    s_add_u32 s79, s78, 7168
    buffer_load_dwordx4 v225, s[40:43], s79 offen offset:1024 lds
    s_add_u32 s80, s78, 14336
    buffer_load_dwordx4 v224, s[40:43], s80 offen offset:2048 lds
    s_add_u32 s81, s78, 21504
    buffer_load_dwordx4 v225, s[40:43], s81 offen offset:3072 lds
    s_waitcnt vmcnt(18)
    s_barrier
    s_add_u32 s77, s11, 5
    s_and_b32 s77, s77, 7
    s_lshl_b32 s77, s77, 2
    s_add_u32 s77, s77, s84
    s_mul_i32 s78, s77, s52
    s_add_u32 m0, s85, 81920
    s_add_u32 s79, s78, s53
    buffer_load_dwordx4 v226, s[44:47], s78 offen lds
    buffer_load_dwordx4 v226, s[44:47], s79 offen offset:1024 lds
    s_add_u32 m0, s85, 90112
    s_nop 0
    buffer_load_dwordx4 v227, s[44:47], s78 offen lds
    buffer_load_dwordx4 v227, s[44:47], s79 offen offset:1024 lds
    s_add_u32 s77, s11, 5
    s_and_b32 s77, s77, 7
    s_lshl_b32 s78, s77, 7
    s_lshl_b32 m0, s84, 12
    s_add_u32 m0, m0, 16384
    s_nop 0
    buffer_load_dwordx4 v224, s[40:43], s78 offen offset:0 lds
    s_add_u32 s79, s78, 7168
    buffer_load_dwordx4 v225, s[40:43], s79 offen offset:1024 lds
    s_add_u32 s80, s78, 14336
    buffer_load_dwordx4 v224, s[40:43], s80 offen offset:2048 lds
    s_add_u32 s81, s78, 21504
    buffer_load_dwordx4 v225, s[40:43], s81 offen offset:3072 lds
    s_mov_b32 s72, s28
    s_mov_b32 s73, s29
    s_mov_b32 s74, 0xac0
    s_mov_b32 s75, 0x20000
    s_lshl_b32 s14, s84, 6
    s_add_u32 s68, s68, s14
    s_add_u32 s69, s69, s14
    s_add_u32 s70, s70, s14
    s_cmp_eq_u32 s9, 1
    s_cselect_b32 s68, 0x7f000000, s68
    s_cselect_b32 s69, 0x7f000000, s69
    s_cselect_b32 s70, s70, 0x7f000000
    v_lshrrev_b32 v236, 1, v253
    buffer_load_ushort v104, v236, s[72:75], s68 offen
    buffer_load_ushort v105, v236, s[72:75], s69 offen
    buffer_load_ushort v106, v236, s[72:75], s70 offen
    s_waitcnt vmcnt(19)
    s_barrier
    s_add_u32 s77, s11, 6
    s_and_b32 s77, s77, 7
    s_lshl_b32 s77, s77, 2
    s_add_u32 s77, s77, s84
    s_mul_i32 s78, s77, s52
    s_add_u32 m0, s85, 98304
    s_add_u32 s79, s78, s53
    buffer_load_dwordx4 v226, s[44:47], s78 offen lds
    buffer_load_dwordx4 v226, s[44:47], s79 offen offset:1024 lds
    s_add_u32 m0, s85, 106496
    s_nop 0
    buffer_load_dwordx4 v227, s[44:47], s78 offen lds
    buffer_load_dwordx4 v227, s[44:47], s79 offen offset:1024 lds
    s_add_u32 s77, s11, 6
    s_and_b32 s77, s77, 7
    s_lshl_b32 s78, s77, 7
    s_lshl_b32 m0, s84, 12
    s_add_u32 m0, m0, 32768
    s_nop 0
    buffer_load_dwordx4 v224, s[40:43], s78 offen offset:0 lds
    s_add_u32 s79, s78, 7168
    buffer_load_dwordx4 v225, s[40:43], s79 offen offset:1024 lds
    s_add_u32 s80, s78, 14336
    buffer_load_dwordx4 v224, s[40:43], s80 offen offset:2048 lds
    s_add_u32 s81, s78, 21504
    buffer_load_dwordx4 v225, s[40:43], s81 offen offset:3072 lds
    v_and_b32 v236, 15, v255
    v_lshrrev_b32 v237, 4, v255
    v_lshlrev_b32 v238, 3, v237
    v_xor_b32 v238, v238, v236
    v_and_b32 v238, 15, v238
    v_mov_b32 v239, 0x3f80
    v_mov_b32 v240, 0x3f800000
    v_cmp_eq_u32 vcc, 0, v238
    s_nop 1
    v_cndmask_b32 v192, 0, v239, vcc
    v_cmp_eq_u32 vcc, 1, v238
    s_nop 1
    v_cndmask_b32 v192, v192, v240, vcc
    v_cmp_eq_u32 vcc, 2, v238
    s_nop 1
    v_cndmask_b32 v193, 0, v239, vcc
    v_cmp_eq_u32 vcc, 3, v238
    s_nop 1
    v_cndmask_b32 v193, v193, v240, vcc
    v_cmp_eq_u32 vcc, 4, v238
    s_nop 1
    v_cndmask_b32 v194, 0, v239, vcc
    v_cmp_eq_u32 vcc, 5, v238
    s_nop 1
    v_cndmask_b32 v194, v194, v240, vcc
    v_cmp_eq_u32 vcc, 6, v238
    s_nop 1
    v_cndmask_b32 v195, 0, v239, vcc
    v_cmp_eq_u32 vcc, 7, v238
    s_nop 1
    v_cndmask_b32 v195, v195, v240, vcc
    v_lshrrev_b32 v239, 3, v236
    v_mul_u32_u24 v196, 8704, v239
    v_lshl_add_u32 v196, v237, 4, v196
    v_lshl_add_u32 v196, v236, 6, v196
    v_lshrrev_b32 v238, 1, v237
    v_mul_u32_u24 v238, 272, v238
    v_and_b32 v237, 1, v237
    v_lshl_add_u32 v238, v237, 3, v238
    s_mul_i32 s14, s84, 1088
    s_add_u32 s14, s14, 155648
    v_add_u32 v238, s14, v238
    v_lshl_add_u32 v197, v236, 4, v238
    v_mul_u32_u24 v239, 544, v239
    v_add_u32 v198, v238, v239
    v_and_b32 v236, 0x33, v255
    v_bfe_u32 v237, v255, 2, 1
    v_lshl_or_b32 v236, v237, 3, v236
    v_bfe_u32 v237, v255, 3, 1
    v_lshl_or_b32 v236, v237, 2, v236
    v_lshlrev_b32 v251, 1, v236
    s_waitcnt vmcnt(19)
    s_barrier
    s_add_u32 s77, s11, 7
    s_and_b32 s77, s77, 7
    s_lshl_b32 s77, s77, 2
    s_add_u32 s77, s77, s84
    s_mul_i32 s78, s77, s52
    s_add_u32 m0, s85, 114688
    s_add_u32 s79, s78, s53
    buffer_load_dwordx4 v226, s[44:47], s78 offen lds
    buffer_load_dwordx4 v226, s[44:47], s79 offen offset:1024 lds
    s_add_u32 m0, s85, 122880
    s_nop 0
    buffer_load_dwordx4 v227, s[44:47], s78 offen lds
    buffer_load_dwordx4 v227, s[44:47], s79 offen offset:1024 lds
    s_add_u32 s77, s11, 7
    s_and_b32 s77, s77, 7
    s_lshl_b32 s78, s77, 7
    s_lshl_b32 m0, s84, 12
    s_add_u32 m0, m0, 49152
    s_nop 0
    buffer_load_dwordx4 v224, s[40:43], s78 offen offset:0 lds
    s_add_u32 s79, s78, 7168
    buffer_load_dwordx4 v225, s[40:43], s79 offen offset:1024 lds
    s_add_u32 s80, s78, 14336
    buffer_load_dwordx4 v224, s[40:43], s80 offen offset:2048 lds
    s_add_u32 s81, s78, 21504
    buffer_load_dwordx4 v225, s[40:43], s81 offen offset:3072 lds
    s_waitcnt vmcnt(19)
    s_barrier
    buffer_load_dwordx4 v[72:75], v254, s[56:59], s6 offen offset:0 sc1
    buffer_load_dwordx4 v[76:79], v254, s[56:59], s6 offen offset:1024 sc1
    buffer_load_dwordx4 v[80:83], v254, s[56:59], s6 offen offset:2048 sc1
    buffer_load_dwordx4 v[84:87], v254, s[56:59], s6 offen offset:3072 sc1
    buffer_load_dwordx4 v[88:91], v254, s[56:59], s7 offen offset:0 sc1
    buffer_load_dwordx4 v[92:95], v254, s[56:59], s7 offen offset:1024 sc1
    buffer_load_dwordx4 v[96:99], v254, s[56:59], s7 offen offset:2048 sc1
    buffer_load_dwordx4 v[100:103], v254, s[56:59], s7 offen offset:3072 sc1
    v_lshrrev_b32 v236, 5, v255
    v_bfe_u32 v237, v255, 2, 2
    v_mul_u32_u24 v236, 4, v236
    v_add_lshl_u32 v244, v236, v237, 7
    v_bfe_u32 v236, v255, 3, 1
    v_lshl_add_u32 v244, v236, 6, v244
    v_bfe_u32 v236, v255, 4, 1
    v_lshl_add_u32 v244, v236, 5, v244
    v_and_b32 v236, 3, v255
    v_lshl_add_u32 v244, v236, 3, v244
    s_lshl_b32 s14, s85, 1
    v_add_u32 v244, s14, v244
    v_xor_b32 v245, 64, v244
    v_add_u32 v246, 65536, v244
    v_add_u32 v247, 65536, v245
    s_lshl_b32 s14, s84, 2
    s_add_u32 s14, s14, 134928
    v_mov_b32 v248, s14
    v_mov_b32 v249, 1
    s_mov_b32 s68, s22
    s_mov_b32 s69, s23
    s_mov_b32 s70, 0x80000
    s_mov_b32 s71, 0x20000
    s_waitcnt vmcnt(16)
    s_barrier
    s_waitcnt vmcnt(8)
    s_barrier
    s_waitcnt vmcnt(0)
    s_mov_b32 s14, 0
LCS_P:
    v_min3_u32 v236, v75, v79, v83
    v_max3_u32 v237, v75, v79, v83
    v_min3_u32 v236, v236, v87, v91
    v_max3_u32 v237, v237, v87, v91
    v_min3_u32 v236, v236, v95, v99
    v_max3_u32 v237, v237, v95, v99
    v_min_u32 v236, v236, v103
    v_max_u32 v237, v237, v103
    v_cmp_eq_u32 vcc, v236, v237
    s_nop 1
    v_cndmask_b32 v236, 0, v236, vcc
    v_cmp_ne_u32 vcc, s3, v236
    s_nop 1
    s_cmp_eq_u64 vcc, 0
    s_nop 1
    s_cbranch_scc1 LCS_G
    s_add_u32 s14, s14, 1
    s_cmp_gt_u32 s14, 0x8000
    s_cbranch_scc1 LCS_G
    s_sleep 8
    buffer_load_dwordx4 v[72:75], v254, s[56:59], s6 offen offset:0 sc1
    buffer_load_dwordx4 v[76:79], v254, s[56:59], s6 offen offset:1024 sc1
    buffer_load_dwordx4 v[80:83], v254, s[56:59], s6 offen offset:2048 sc1
    buffer_load_dwordx4 v[84:87], v254, s[56:59], s6 offen offset:3072 sc1
    buffer_load_dwordx4 v[88:91], v254, s[56:59], s7 offen offset:0 sc1
    buffer_load_dwordx4 v[92:95], v254, s[56:59], s7 offen offset:1024 sc1
    buffer_load_dwordx4 v[96:99], v254, s[56:59], s7 offen offset:2048 sc1
    buffer_load_dwordx4 v[100:103], v254, s[56:59], s7 offen offset:3072 sc1
    s_waitcnt vmcnt(0)
    s_branch LCS_P
LCS_G:
    v_add_f32 v72, v72, v88
    v_add_f32 v73, v73, v89
    v_add_f32 v74, v74, v90
    v_add_f32 v76, v76, v92
    v_add_f32 v77, v77, v93
    v_add_f32 v78, v78, v94
    v_add_f32 v80, v80, v96
    v_add_f32 v81, v81, v97
    v_add_f32 v82, v82, v98
    v_add_f32 v84, v84, v100
    v_add_f32 v85, v85, v101
    v_add_f32 v86, v86, v102
    v_add_f32 v72, v72, v80
    v_add_f32 v73, v73, v81
    v_add_f32 v74, v74, v82
    v_add_f32 v76, v76, v84
    v_add_f32 v77, v77, v85
    v_add_f32 v78, v78, v86
    v_add_f32 v72, v72, v76
    v_add_f32 v73, v73, v77
    v_add_f32 v74, v74, v78
    v_mov_b32 v76, v72
    v_mov_b32 v77, v73
    v_mov_b32 v78, v74
    v_permlane32_swap_b32 v72, v76
    v_permlane32_swap_b32 v73, v77
    v_permlane32_swap_b32 v74, v78
    v_add_f32 v72, v72, v76
    v_add_f32 v73, v73, v77
    v_add_f32 v74, v74, v78
    s_mul_i32 s14, s84, 768
    s_add_u32 s14, s14, 131072
    v_lshl_add_u32 v236, v253, 1, s14
    v_cvt_pk_bf16_f32 v80, v72, v72
    v_lshlrev_b32 v80, 16, v80
    v_sub_f32 v80, v72, v80
    v_cvt_pk_bf16_f32 v80, v72, v80
    v_mov_b32 v81, v104
    ds_write_b64 v236, v[80:81] offset:0
    v_cvt_pk_bf16_f32 v82, v73, v73
    v_lshlrev_b32 v82, 16, v82
    v_sub_f32 v82, v73, v82
    v_cvt_pk_bf16_f32 v82, v73, v82
    v_mov_b32 v83, v105
    ds_write_b64 v236, v[82:83] offset:256
    v_cvt_pk_bf16_f32 v84, v74, v74
    v_lshlrev_b32 v84, 16, v84
    v_sub_f32 v84, v74, v84
    v_cvt_pk_bf16_f32 v84, v74, v84
    v_mov_b32 v85, v106
    ds_write_b64 v236, v[84:85] offset:512
    s_waitcnt lgkmcnt(0)
    s_nop 0
    s_branch L_JOIN
LB_START:
    s_lshl_b32 s7, s5, 1
    s_add_u32 s7, s7, s84
    s_lshl_b32 s7, s7, 9
    s_add_u32 s7, s7, 0xc7fc00
    v_lshlrev_b32 v234, 3, v255
    s_add_u32 s77, s11, 3
    s_and_b32 s77, s77, 7
    s_lshl_b32 s77, s77, 2
    s_add_u32 s77, s77, s84
    s_mul_i32 s78, s77, s52
    s_add_u32 m0, s85, 114688
    s_add_u32 s79, s78, s53
    buffer_load_dwordx4 v226, s[44:47], s78 offen lds
    buffer_load_dwordx4 v226, s[44:47], s79 offen offset:1024 lds
    s_add_u32 m0, s85, 122880
    s_nop 0
    buffer_load_dwordx4 v227, s[44:47], s78 offen lds
    buffer_load_dwordx4 v227, s[44:47], s79 offen offset:1024 lds
    s_add_u32 s77, s11, 3
    s_and_b32 s77, s77, 7
    s_lshl_b32 s78, s77, 7
    s_lshl_b32 m0, s84, 12
    s_add_u32 m0, m0, 49152
    s_nop 0
    buffer_load_dwordx4 v224, s[40:43], s78 offen offset:0 lds
    s_add_u32 s79, s78, 7168
    buffer_load_dwordx4 v225, s[40:43], s79 offen offset:1024 lds
    s_add_u32 s80, s78, 14336
    buffer_load_dwordx4 v224, s[40:43], s80 offen offset:2048 lds
    s_add_u32 s81, s78, 21504
    buffer_load_dwordx4 v225, s[40:43], s81 offen offset:3072 lds
    s_waitcnt vmcnt(18)
    s_barrier
    s_add_u32 s77, s11, 4
    s_and_b32 s77, s77, 7
    s_lshl_b32 s77, s77, 2
    s_add_u32 s77, s77, s84
    s_mul_i32 s78, s77, s52
    s_add_u32 m0, s85, 65536
    s_add_u32 s79, s78, s53
    buffer_load_dwordx4 v226, s[44:47], s78 offen lds
    buffer_load_dwordx4 v226, s[44:47], s79 offen offset:1024 lds
    s_add_u32 m0, s85, 73728
    s_nop 0
    buffer_load_dwordx4 v227, s[44:47], s78 offen lds
    buffer_load_dwordx4 v227, s[44:47], s79 offen offset:1024 lds
    s_add_u32 s77, s11, 4
    s_and_b32 s77, s77, 7
    s_lshl_b32 s78, s77, 7
    s_lshl_b32 m0, s84, 12
    s_nop 0
    buffer_load_dwordx4 v224, s[40:43], s78 offen offset:0 lds
    s_add_u32 s79, s78, 7168
    buffer_load_dwordx4 v225, s[40:43], s79 offen offset:1024 lds
    s_add_u32 s80, s78, 14336
    buffer_load_dwordx4 v224, s[40:43], s80 offen offset:2048 lds
    s_add_u32 s81, s78, 21504
    buffer_load_dwordx4 v225, s[40:43], s81 offen offset:3072 lds
    s_waitcnt vmcnt(17)
    s_barrier
    s_add_u32 s77, s11, 5
    s_and_b32 s77, s77, 7
    s_lshl_b32 s77, s77, 2
    s_add_u32 s77, s77, s84
    s_mul_i32 s78, s77, s52
    s_add_u32 m0, s85, 81920
    s_add_u32 s79, s78, s53
    buffer_load_dwordx4 v226, s[44:47], s78 offen lds
    buffer_load_dwordx4 v226, s[44:47], s79 offen offset:1024 lds
    s_add_u32 m0, s85, 90112
    s_nop 0
    buffer_load_dwordx4 v227, s[44:47], s78 offen lds
    buffer_load_dwordx4 v227, s[44:47], s79 offen offset:1024 lds
    s_add_u32 s77, s11, 5
    s_and_b32 s77, s77, 7
    s_lshl_b32 s78, s77, 7
    s_lshl_b32 m0, s84, 12
    s_add_u32 m0, m0, 16384
    s_nop 0
    buffer_load_dwordx4 v224, s[40:43], s78 offen offset:0 lds
    s_add_u32 s79, s78, 7168
    buffer_load_dwordx4 v225, s[40:43], s79 offen offset:1024 lds
    s_add_u32 s80, s78, 14336
    buffer_load_dwordx4 v224, s[40:43], s80 offen offset:2048 lds
    s_add_u32 s81, s78, 21504
    buffer_load_dwordx4 v225, s[40:43], s81 offen offset:3072 lds
    s_mov_b32 s72, s20
    s_mov_b32 s73, s21
    s_mov_b32 s74, 0x4000
    s_mov_b32 s75, 0x20000
    s_lshl_b32 s14, s39, 1
    s_add_u32 s14, s14, s84
    s_lshl_b32 s14, s14, 10
    s_sub_u32 s14, s14, 2048
    s_lshr_b32 s15, s85, 1
    s_add_u32 m0, s15, 135168
    s_nop 0
    buffer_load_dwordx4 v254, s[72:75], s14 offen lds
    s_waitcnt vmcnt(17)
    s_barrier
    s_add_u32 s77, s11, 6
    s_and_b32 s77, s77, 7
    s_lshl_b32 s77, s77, 2
    s_add_u32 s77, s77, s84
    s_mul_i32 s78, s77, s52
    s_add_u32 m0, s85, 98304
    s_add_u32 s79, s78, s53
    buffer_load_dwordx4 v226, s[44:47], s78 offen lds
    buffer_load_dwordx4 v226, s[44:47], s79 offen offset:1024 lds
    s_add_u32 m0, s85, 106496
    s_nop 0
    buffer_load_dwordx4 v227, s[44:47], s78 offen lds
    buffer_load_dwordx4 v227, s[44:47], s79 offen offset:1024 lds
    s_add_u32 s77, s11, 6
    s_and_b32 s77, s77, 7
    s_lshl_b32 s78, s77, 7
    s_lshl_b32 m0, s84, 12
    s_add_u32 m0, m0, 32768
    s_nop 0
    buffer_load_dwordx4 v224, s[40:43], s78 offen offset:0 lds
    s_add_u32 s79, s78, 7168
    buffer_load_dwordx4 v225, s[40:43], s79 offen offset:1024 lds
    s_add_u32 s80, s78, 14336
    buffer_load_dwordx4 v224, s[40:43], s80 offen offset:2048 lds
    s_add_u32 s81, s78, 21504
    buffer_load_dwordx4 v225, s[40:43], s81 offen offset:3072 lds
    v_and_b32 v236, 15, v255
    v_lshrrev_b32 v237, 4, v255
    v_lshlrev_b32 v238, 3, v237
    v_xor_b32 v238, v238, v236
    v_and_b32 v238, 15, v238
    v_mov_b32 v239, 0x3f80
    v_mov_b32 v240, 0x3f800000
    v_cmp_eq_u32 vcc, 0, v238
    s_nop 1
    v_cndmask_b32 v192, 0, v239, vcc
    v_cmp_eq_u32 vcc, 1, v238
    s_nop 1
    v_cndmask_b32 v192, v192, v240, vcc
    v_cmp_eq_u32 vcc, 2, v238
    s_nop 1
    v_cndmask_b32 v193, 0, v239, vcc
    v_cmp_eq_u32 vcc, 3, v238
    s_nop 1
    v_cndmask_b32 v193, v193, v240, vcc
    v_cmp_eq_u32 vcc, 4, v238
    s_nop 1
    v_cndmask_b32 v194, 0, v239, vcc
    v_cmp_eq_u32 vcc, 5, v238
    s_nop 1
    v_cndmask_b32 v194, v194, v240, vcc
    v_cmp_eq_u32 vcc, 6, v238
    s_nop 1
    v_cndmask_b32 v195, 0, v239, vcc
    v_cmp_eq_u32 vcc, 7, v238
    s_nop 1
    v_cndmask_b32 v195, v195, v240, vcc
    v_lshrrev_b32 v239, 3, v236
    v_mul_u32_u24 v196, 8704, v239
    v_lshl_add_u32 v196, v237, 4, v196
    v_lshl_add_u32 v196, v236, 6, v196
    v_lshrrev_b32 v238, 1, v237
    v_mul_u32_u24 v238, 272, v238
    v_and_b32 v237, 1, v237
    v_lshl_add_u32 v238, v237, 3, v238
    s_mul_i32 s14, s84, 1088
    s_add_u32 s14, s14, 155648
    v_add_u32 v238, s14, v238
    v_lshl_add_u32 v197, v236, 4, v238
    v_mul_u32_u24 v239, 544, v239
    v_add_u32 v198, v238, v239
    v_and_b32 v236, 0x33, v255
    v_bfe_u32 v237, v255, 2, 1
    v_lshl_or_b32 v236, v237, 3, v236
    v_bfe_u32 v237, v255, 3, 1
    v_lshl_or_b32 v236, v237, 2, v236
    v_lshlrev_b32 v251, 1, v236
    s_waitcnt vmcnt(17)
    s_barrier
    s_add_u32 s77, s11, 7
    s_and_b32 s77, s77, 7
    s_lshl_b32 s77, s77, 2
    s_add_u32 s77, s77, s84
    s_mul_i32 s78, s77, s52
    s_add_u32 m0, s85, 114688
    s_add_u32 s79, s78, s53
    buffer_load_dwordx4 v226, s[44:47], s78 offen lds
    buffer_load_dwordx4 v226, s[44:47], s79 offen offset:1024 lds
    s_add_u32 m0, s85, 122880
    s_nop 0
    buffer_load_dwordx4 v227, s[44:47], s78 offen lds
    buffer_load_dwordx4 v227, s[44:47], s79 offen offset:1024 lds
    s_add_u32 s77, s11, 7
    s_and_b32 s77, s77, 7
    s_lshl_b32 s78, s77, 7
    s_lshl_b32 m0, s84, 12
    s_add_u32 m0, m0, 49152
    s_nop 0
    buffer_load_dwordx4 v224, s[40:43], s78 offen offset:0 lds
    s_add_u32 s79, s78, 7168
    buffer_load_dwordx4 v225, s[40:43], s79 offen offset:1024 lds
    s_add_u32 s80, s78, 14336
    buffer_load_dwordx4 v224, s[40:43], s80 offen offset:2048 lds
    s_add_u32 s81, s78, 21504
    buffer_load_dwordx4 v225, s[40:43], s81 offen offset:3072 lds
    s_waitcnt vmcnt(17)
    s_barrier
    buffer_load_dwordx2 v[72:73], v234, s[56:59], s7 offen sc1
    v_lshrrev_b32 v236, 5, v255
    v_bfe_u32 v237, v255, 2, 2
    v_mul_u32_u24 v236, 4, v236
    v_add_lshl_u32 v244, v236, v237, 7
    v_bfe_u32 v236, v255, 3, 1
    v_lshl_add_u32 v244, v236, 6, v244
    v_bfe_u32 v236, v255, 4, 1
    v_lshl_add_u32 v244, v236, 5, v244
    v_and_b32 v236, 3, v255
    v_lshl_add_u32 v244, v236, 3, v244
    s_lshl_b32 s14, s85, 1
    v_add_u32 v244, s14, v244
    v_xor_b32 v245, 64, v244
    v_add_u32 v246, 65536, v244
    v_add_u32 v247, 65536, v245
    s_lshl_b32 s14, s84, 2
    s_add_u32 s14, s14, 134928
    v_mov_b32 v248, s14
    v_mov_b32 v249, 1
    s_mov_b32 s68, s22
    s_mov_b32 s69, s23
    s_mov_b32 s70, 0x80000
    s_mov_b32 s71, 0x20000
    s_waitcnt vmcnt(9)
    s_barrier
    s_waitcnt vmcnt(1)
    s_barrier
    s_waitcnt vmcnt(0)
    s_mov_b32 s14, 0
LST_P:
    v_cmp_ne_u32 vcc, s3, v73
    s_nop 1
    s_cmp_eq_u64 vcc, 0
    s_nop 1
    s_cbranch_scc1 LST_G
    s_add_u32 s14, s14, 1
    s_cmp_gt_u32 s14, 0x8000
    s_cbranch_scc1 LST_G
    s_sleep 8
    buffer_load_dwordx2 v[72:73], v234, s[56:59], s7 offen sc1
    s_waitcnt vmcnt(0)
    s_branch LST_P
LST_G:
    v_and_b32 v236, 0xffff, v72
    v_lshl_or_b32 v236, v72, 16, v236
    v_lshrrev_b32 v237, 16, v72
    v_and_b32 v72, 0xffff0000, v72
    v_rcp_f32 v238, v72
    s_lshr_b32 s14, s85, 2
    s_add_u32 s14, s14, 132096
    v_add_u32 v239, s14, v234
    ds_write_b64 v239, v[236:237]
    s_lshr_b32 s14, s85, 3
    s_add_u32 s14, s14, 133632
    v_lshl_add_u32 v239, v255, 2, s14
    ds_write_b32 v239, v238
    s_lshr_b32 s14, s85, 4
    s_add_u32 s14, s14, 134400
    v_add_u32 v239, s14, v251
    ds_write_b16 v239, v237
    v_cmp_eq_u32 vcc, 0, v253
    s_nop 1
    v_cndmask_b32 v240, 0, v230, vcc
    v_add_u32 v242, 134912, v253
    ds_write_b32 v242, v240
    s_waitcnt lgkmcnt(0)
    s_nop 0
L_JOIN:
    s_barrier
    s_add_u32 s77, s11, 1
    s_and_b32 s77, s77, 7
    s_lshl_b32 s77, s77, 2
    s_add_u32 s77, s77, s84
    s_mul_i32 s78, s77, s54
    s_add_u32 m0, s85, 147456
    s_add_u32 s79, s78, s55
    buffer_load_dwordx4 v228, s[48:51], s78 offen lds
    buffer_load_dwordx4 v228, s[48:51], s79 offen offset:1024 lds
    s_add_u32 s77, s11, 2
    s_and_b32 s77, s77, 7
    s_lshl_b32 s77, s77, 2
    s_add_u32 s77, s77, s84
    s_mul_i32 s78, s77, s54
    s_add_u32 m0, s85, 0
    s_add_u32 s79, s78, s55
    buffer_load_dwordx4 v228, s[48:51], s78 offen lds
    buffer_load_dwordx4 v228, s[48:51], s79 offen offset:1024 lds
    s_add_u32 s77, s11, 3
    s_and_b32 s77, s77, 7
    s_lshl_b32 s77, s77, 2
    s_add_u32 s77, s77, s84
    s_mul_i32 s78, s77, s54
    s_add_u32 m0, s85, 8192
    s_add_u32 s79, s78, s55
    buffer_load_dwordx4 v228, s[48:51], s78 offen lds
    buffer_load_dwordx4 v228, s[48:51], s79 offen offset:1024 lds
    s_add_u32 s77, s11, 4
    s_and_b32 s77, s77, 7
    s_lshl_b32 s77, s77, 2
    s_add_u32 s77, s77, s84
    s_mul_i32 s78, s77, s54
    s_add_u32 m0, s85, 65536
    s_add_u32 s79, s78, s55
    buffer_load_dwordx4 v228, s[48:51], s78 offen lds
    buffer_load_dwordx4 v228, s[48:51], s79 offen offset:1024 lds
    s_add_u32 s77, s11, 5
    s_and_b32 s77, s77, 7
    s_lshl_b32 s77, s77, 2
    s_add_u32 s77, s77, s84
    s_mul_i32 s78, s77, s54
    s_add_u32 m0, s85, 73728
    s_add_u32 s79, s78, s55
    buffer_load_dwordx4 v228, s[48:51], s78 offen lds
    buffer_load_dwordx4 v228, s[48:51], s79 offen offset:1024 lds
    s_add_u32 s77, s11, 6
    s_and_b32 s77, s77, 7
    s_lshl_b32 s77, s77, 2
    s_add_u32 s77, s77, s84
    s_mul_i32 s78, s77, s54
    s_add_u32 m0, s85, 16384
    s_add_u32 s79, s78, s55
    buffer_load_dwordx4 v228, s[48:51], s78 offen lds
    buffer_load_dwordx4 v228, s[48:51], s79 offen offset:1024 lds
    s_add_u32 s77, s11, 7
    s_and_b32 s77, s77, 7
    s_lshl_b32 s77, s77, 2
    s_add_u32 s77, s77, s84
    s_mul_i32 s78, s77, s54
    s_add_u32 m0, s85, 24576
    s_add_u32 s79, s78, s55
    buffer_load_dwordx4 v228, s[48:51], s78 offen lds
    buffer_load_dwordx4 v228, s[48:51], s79 offen offset:1024 lds
    s_cmp_eq_u32 s9, 1
    s_cbranch_scc1 LX_START
    s_lshl_b32 s86, s12, 3
    s_add_u32 s86, s86, s84
    s_lshl_b32 s86, s86, 7
    s_add_u32 s86, s86, 0xc90000
    s_mul_i32 s87, s12, 245760
    s_lshl_b32 s82, s84, 15
    s_add_u32 s82, s82, s87
    s_mul_i32 s83, s84, 12288
    s_add_u32 s83, s83, s87
    s_waitcnt vmcnt(0)
    ds_write_b32 v248, v249
    s_mul_i32 s78, s84, 262144
    s_lshl_b32 m0, s84, 12
    s_add_u32 m0, m0, 81920
    s_nop 0
    buffer_load_dwordx4 v252, s[64:67], s78 offen offset:0 lds
    s_add_u32 s79, s78, 7168
    buffer_load_dwordx4 v252, s[64:67], s79 offen offset:1024 lds
    s_add_u32 s80, s78, 14336
    buffer_load_dwordx4 v252, s[64:67], s80 offen offset:2048 lds
    s_add_u32 s81, s78, 21504
    buffer_load_dwordx4 v252, s[64:67], s81 offen offset:3072 lds
    s_mul_i32 s78, s84, 262144
    s_add_u32 s78, s78, 32768
    s_lshl_b32 m0, s84, 12
    s_add_u32 m0, m0, 98304
    s_nop 0
    buffer_load_dwordx4 v252, s[64:67], s78 offen offset:0 lds
    s_add_u32 s79, s78, 7168
    buffer_load_dwordx4 v252, s[64:67], s79 offen offset:1024 lds
    s_add_u32 s80, s78, 14336
    buffer_load_dwordx4 v252, s[64:67], s80 offen offset:2048 lds
    s_add_u32 s81, s78, 21504
    buffer_load_dwordx4 v252, s[64:67], s81 offen offset:3072 lds
    s_mul_i32 s78, s84, 262144
    s_add_u32 s78, s78, 131072
    s_lshl_b32 m0, s84, 12
    s_add_u32 m0, m0, 32768
    s_nop 0
    buffer_load_dwordx4 v252, s[64:67], s78 offen offset:0 lds
    s_add_u32 s79, s78, 7168
    buffer_load_dwordx4 v252, s[64:67], s79 offen offset:1024 lds
    s_add_u32 s80, s78, 14336
    buffer_load_dwordx4 v252, s[64:67], s80 offen offset:2048 lds
    s_add_u32 s81, s78, 21504
    buffer_load_dwordx4 v252, s[64:67], s81 offen offset:3072 lds
    s_mul_i32 s78, s84, 262144
    s_add_u32 s78, s78, 163840
    s_lshl_b32 m0, s84, 12
    s_add_u32 m0, m0, 49152
    s_nop 0
    buffer_load_dwordx4 v252, s[64:67], s78 offen offset:0 lds
    s_add_u32 s79, s78, 7168
    buffer_load_dwordx4 v252, s[64:67], s79 offen offset:1024 lds
    s_add_u32 s80, s78, 14336
    buffer_load_dwordx4 v252, s[64:67], s80 offen offset:2048 lds
    s_add_u32 s81, s78, 21504
    buffer_load_dwordx4 v252, s[64:67], s81 offen offset:3072 lds
    s_waitcnt vmcnt(12)
    ds_read_b64_tr_b16 v[64:65], v246 offset:16384
    ds_read_b64_tr_b16 v[66:67], v246 offset:17408
    ds_read_b64_tr_b16 v[68:69], v247 offset:16384
    ds_read_b64_tr_b16 v[70:71], v247 offset:17408
    ds_read_b64_tr_b16 v[72:73], v246 offset:18432
    ds_read_b64_tr_b16 v[74:75], v246 offset:19456
    ds_read_b64_tr_b16 v[76:77], v247 offset:18432
    ds_read_b64_tr_b16 v[78:79], v247 offset:19456
    s_waitcnt lgkmcnt(0)
    s_mul_i32 s78, s84, 262144
    s_add_u32 s78, s78, 65536
    s_lshl_b32 m0, s84, 12
    s_add_u32 m0, m0, 114688
    s_nop 0
    buffer_load_dwordx4 v252, s[64:67], s78 offen offset:0 lds
    s_add_u32 s79, s78, 7168
    buffer_load_dwordx4 v252, s[64:67], s79 offen offset:1024 lds
    s_add_u32 s80, s78, 14336
    buffer_load_dwordx4 v252, s[64:67], s80 offen offset:2048 lds
    s_add_u32 s81, s78, 21504
    buffer_load_dwordx4 v252, s[64:67], s81 offen offset:3072 lds
    s_waitcnt vmcnt(12)
    ds_read_b64_tr_b16 v[80:81], v246 offset:32768
    ds_read_b64_tr_b16 v[82:83], v246 offset:33792
    ds_read_b64_tr_b16 v[84:85], v247 offset:32768
    ds_read_b64_tr_b16 v[86:87], v247 offset:33792
    ds_read_b64_tr_b16 v[88:89], v246 offset:34816
    ds_read_b64_tr_b16 v[90:91], v246 offset:35840
    ds_read_b64_tr_b16 v[92:93], v247 offset:34816
    ds_read_b64_tr_b16 v[94:95], v247 offset:35840
    s_waitcnt lgkmcnt(0)
    s_mul_i32 s78, s84, 262144
    s_add_u32 s78, s78, 98304
    s_lshl_b32 m0, s84, 12
    s_add_u32 m0, m0, 81920
    s_nop 0
    buffer_load_dwordx4 v252, s[64:67], s78 offen offset:0 lds
    s_add_u32 s79, s78, 7168
    buffer_load_dwordx4 v252, s[64:67], s79 offen offset:1024 lds
    s_add_u32 s80, s78, 14336
    buffer_load_dwordx4 v252, s[64:67], s80 offen offset:2048 lds
    s_add_u32 s81, s78, 21504
    buffer_load_dwordx4 v252, s[64:67], s81 offen offset:3072 lds
    s_waitcnt vmcnt(12)
    ds_read_b64_tr_b16 v[96:97], v244 offset:32768
    ds_read_b64_tr_b16 v[98:99], v244 offset:33792
    ds_read_b64_tr_b16 v[100:101], v245 offset:32768
    ds_read_b64_tr_b16 v[102:103], v245 offset:33792
    ds_read_b64_tr_b16 v[104:105], v244 offset:34816
    ds_read_b64_tr_b16 v[106:107], v244 offset:35840
    ds_read_b64_tr_b16 v[108:109], v245 offset:34816
    ds_read_b64_tr_b16 v[110:111], v245 offset:35840
    s_waitcnt lgkmcnt(0)
    s_mul_i32 s78, s84, 262144
    s_add_u32 s78, s78, 196608
    s_lshl_b32 m0, s84, 12
    s_add_u32 m0, m0, 98304
    s_nop 0
    buffer_load_dwordx4 v252, s[64:67], s78 offen offset:0 lds
    s_add_u32 s79, s78, 7168
    buffer_load_dwordx4 v252, s[64:67], s79 offen offset:1024 lds
    s_add_u32 s80, s78, 14336
    buffer_load_dwordx4 v252, s[64:67], s80 offen offset:2048 lds
    s_add_u32 s81, s78, 21504
    buffer_load_dwordx4 v252, s[64:67], s81 offen offset:3072 lds
    s_waitcnt vmcnt(12)
    ds_read_b64_tr_b16 v[112:113], v244 offset:49152
    ds_read_b64_tr_b16 v[114:115], v244 offset:50176
    ds_read_b64_tr_b16 v[116:117], v245 offset:49152
    ds_read_b64_tr_b16 v[118:119], v245 offset:50176
    ds_read_b64_tr_b16 v[120:121], v244 offset:51200
    ds_read_b64_tr_b16 v[122:123], v244 offset:52224
    ds_read_b64_tr_b16 v[124:125], v245 offset:51200
    ds_read_b64_tr_b16 v[126:127], v245 offset:52224
    s_waitcnt lgkmcnt(0)
    s_lshl_b32 s78, s84, 17
    s_lshl_b32 m0, s84, 12
    s_add_u32 m0, m0, 32768
    s_nop 0
    buffer_load_dwordx4 v252, s[68:71], s78 offen offset:0 lds
    s_add_u32 s79, s78, 7168
    buffer_load_dwordx4 v252, s[68:71], s79 offen offset:1024 lds
    s_add_u32 s80, s78, 14336
    buffer_load_dwordx4 v252, s[68:71], s80 offen offset:2048 lds
    s_add_u32 s81, s78, 21504
    buffer_load_dwordx4 v252, s[68:71], s81 offen offset:3072 lds
    s_waitcnt vmcnt(12)
    ds_read_b64_tr_b16 v[128:129], v246 offset:49152
    ds_read_b64_tr_b16 v[130:131], v246 offset:50176
    ds_read_b64_tr_b16 v[132:133], v247 offset:49152
    ds_read_b64_tr_b16 v[134:135], v247 offset:50176
    ds_read_b64_tr_b16 v[136:137], v246 offset:51200
    ds_read_b64_tr_b16 v[138:139], v246 offset:52224
    ds_read_b64_tr_b16 v[140:141], v247 offset:51200
    ds_read_b64_tr_b16 v[142:143], v247 offset:52224
    s_waitcnt lgkmcnt(0)
    s_lshl_b32 s78, s84, 17
    s_add_u32 s78, s78, 32768
    s_lshl_b32 m0, s84, 12
    s_add_u32 m0, m0, 49152
    s_nop 0
    buffer_load_dwordx4 v252, s[68:71], s78 offen offset:0 lds
    s_add_u32 s79, s78, 7168
    buffer_load_dwordx4 v252, s[68:71], s79 offen offset:1024 lds
    s_add_u32 s80, s78, 14336
    buffer_load_dwordx4 v252, s[68:71], s80 offen offset:2048 lds
    s_add_u32 s81, s78, 21504
    buffer_load_dwordx4 v252, s[68:71], s81 offen offset:3072 lds
    s_waitcnt vmcnt(12)
    ds_read_b64_tr_b16 v[144:145], v246 offset:16384
    ds_read_b64_tr_b16 v[146:147], v246 offset:17408
    ds_read_b64_tr_b16 v[148:149], v247 offset:16384
    ds_read_b64_tr_b16 v[150:151], v247 offset:17408
    ds_read_b64_tr_b16 v[152:153], v246 offset:18432
    ds_read_b64_tr_b16 v[154:155], v246 offset:19456
    ds_read_b64_tr_b16 v[156:157], v247 offset:18432
    ds_read_b64_tr_b16 v[158:159], v247 offset:19456
    s_waitcnt lgkmcnt(0)
    s_lshl_b32 s78, s84, 17
    s_add_u32 s78, s78, 98304
    s_lshl_b32 m0, s84, 12
    s_add_u32 m0, m0, 114688
    s_nop 0
    buffer_load_dwordx4 v252, s[68:71], s78 offen offset:0 lds
    s_add_u32 s79, s78, 7168
    buffer_load_dwordx4 v252, s[68:71], s79 offen offset:1024 lds
    s_add_u32 s80, s78, 14336
    buffer_load_dwordx4 v252, s[68:71], s80 offen offset:2048 lds
    s_add_u32 s81, s78, 21504
    buffer_load_dwordx4 v252, s[68:71], s81 offen offset:3072 lds
    buffer_load_dword v250, v253, s[56:59], s86 offen sc1
    s_waitcnt vmcnt(13)
    ds_read_b64_tr_b16 v[160:161], v246 offset:32768
    ds_read_b64_tr_b16 v[162:163], v246 offset:33792
    ds_read_b64_tr_b16 v[164:165], v247 offset:32768
    ds_read_b64_tr_b16 v[166:167], v247 offset:33792
    ds_read_b64_tr_b16 v[168:169], v246 offset:34816
    ds_read_b64_tr_b16 v[170:171], v246 offset:35840
    ds_read_b64_tr_b16 v[172:173], v247 offset:34816
    ds_read_b64_tr_b16 v[174:175], v247 offset:35840
    s_waitcnt lgkmcnt(0)
    s_mul_i32 s78, s84, 262144
    s_add_u32 s78, s78, 229376
    s_lshl_b32 m0, s84, 12
    s_add_u32 m0, m0, 81920
    s_nop 0
    buffer_load_dwordx4 v252, s[64:67], s78 offen offset:0 lds
    s_add_u32 s79, s78, 7168
    buffer_load_dwordx4 v252, s[64:67], s79 offen offset:1024 lds
    s_add_u32 s80, s78, 14336
    buffer_load_dwordx4 v252, s[64:67], s80 offen offset:2048 lds
    s_add_u32 s81, s78, 21504
    buffer_load_dwordx4 v252, s[64:67], s81 offen offset:3072 lds
    s_waitcnt vmcnt(13)
    s_lshl_b32 s78, s84, 17
    s_add_u32 s78, s78, 65536
    s_lshl_b32 m0, s84, 12
    s_add_u32 m0, m0, 98304
    s_nop 0
    buffer_load_dwordx4 v252, s[68:71], s78 offen offset:0 lds
    s_add_u32 s79, s78, 7168
    buffer_load_dwordx4 v252, s[68:71], s79 offen offset:1024 lds
    s_add_u32 s80, s78, 14336
    buffer_load_dwordx4 v252, s[68:71], s80 offen offset:2048 lds
    s_add_u32 s81, s78, 21504
    buffer_load_dwordx4 v252, s[68:71], s81 offen offset:3072 lds
    s_lshl_b32 s14, s39, 2
    s_add_u32 s14, s14, s84
    s_lshl_b32 s78, s14, 7
    s_add_u32 s78, s78, 0x8a0000
    buffer_load_dword v199, v253, s[56:59], s78 offen sc1
    s_mul_i32 s14, s14, 18432
    s_add_u32 s79, s14, 0x800000
    s_add_u32 s80, s14, 0x802400
    s_add_u32 s81, s14, 0x801000
    s_add_u32 s6, s14, 0x803400
    s_add_u32 s7, s14, 0x802000
    s_waitcnt vmcnt(9)
    s_mov_b32 s14, 0
LA00_P:
    v_cmp_ne_u32 vcc, s3, v250
    s_nop 1
    s_and_b32 vcc_lo, vcc_lo, 0xf
    s_cmp_eq_u32 vcc_lo, 0
    s_nop 0
    s_cbranch_scc1 LA00_G
    s_add_u32 s14, s14, 1
    s_cmp_gt_u32 s14, 0x8000
    s_cbranch_scc1 LA00_G
    s_sleep 8
    buffer_load_dword v250, v253, s[56:59], s86 offen sc1
    s_waitcnt vmcnt(0)
    s_branch LA00_P
LA00_G:
    s_add_u32 s15, s82, 0
    buffer_load_dwordx4 v[208:211], v254, s[56:59], s15 offen offset:0 sc1
    buffer_load_dwordx4 v[212:215], v254, s[56:59], s15 offen offset:1024 sc1
    buffer_load_dwordx4 v[216:219], v254, s[56:59], s15 offen offset:2048 sc1
    buffer_load_dwordx4 v[220:223], v254, s[56:59], s15 offen offset:3072 sc1
    s_add_u32 s15, s82, 4096
    buffer_load_dwordx4 v[224:227], v254, s[56:59], s15 offen offset:0 sc1
    buffer_load_dwordx4 v[228:231], v254, s[56:59], s15 offen offset:1024 sc1
    buffer_load_dwordx4 v[232:235], v254, s[56:59], s15 offen offset:2048 sc1
    buffer_load_dwordx4 v[236:239], v254, s[56:59], s15 offen offset:3072 sc1
    s_waitcnt vmcnt(8)
    s_mov_b32 s14, 0
LK_P:
    v_cmp_ne_u32 vcc, s3, v199
    s_nop 1
    s_and_b32 vcc_lo, vcc_lo, 0xffff
    s_cmp_eq_u32 vcc_lo, 0
    s_nop 0
    s_cbranch_scc1 LK_G
    s_add_u32 s14, s14, 1
    s_cmp_gt_u32 s14, 0x8000
    s_cbranch_scc1 LK_G
    s_sleep 8
    buffer_load_dword v199, v253, s[56:59], s78 offen sc1
    s_waitcnt vmcnt(0)
    s_branch LK_P
LK_G:
    buffer_load_dwordx4 v[176:179], v196, s[56:59], s7 offen sc1
    buffer_load_dwordx4 v[0:3], v254, s[56:59], s79 offen offset:0 sc1
    buffer_load_dwordx4 v[4:7], v254, s[56:59], s80 offen offset:0 sc1
    buffer_load_dwordx4 v[8:11], v254, s[56:59], s79 offen offset:1024 sc1
    buffer_load_dwordx4 v[12:15], v254, s[56:59], s80 offen offset:1024 sc1
    buffer_load_dwordx4 v[16:19], v254, s[56:59], s79 offen offset:2048 sc1
    buffer_load_dwordx4 v[20:23], v254, s[56:59], s80 offen offset:2048 sc1
    buffer_load_dwordx4 v[24:27], v254, s[56:59], s79 offen offset:3072 sc1
    buffer_load_dwordx4 v[28:31], v254, s[56:59], s80 offen offset:3072 sc1
    buffer_load_dwordx4 v[32:35], v254, s[56:59], s81 offen offset:0 sc1
    buffer_load_dwordx4 v[36:39], v254, s[56:59], s6 offen offset:0 sc1
    buffer_load_dwordx4 v[40:43], v254, s[56:59], s81 offen offset:1024 sc1
    buffer_load_dwordx4 v[44:47], v254, s[56:59], s6 offen offset:1024 sc1
    buffer_load_dwordx4 v[48:51], v254, s[56:59], s81 offen offset:2048 sc1
    buffer_load_dwordx4 v[52:55], v254, s[56:59], s6 offen offset:2048 sc1
    buffer_load_dwordx4 v[56:59], v254, s[56:59], s81 offen offset:3072 sc1
    buffer_load_dwordx4 v[60:63], v254, s[56:59], s6 offen offset:3072 sc1
VK_B:
    s_waitcnt vmcnt(16)
    v_mfma_f32_16x16x32_bf16 v[188:191], v[192:195], v[176:179], 0
    s_waitcnt vmcnt(15)
    v_mfma_f32_16x16x32_bf16 v[180:183], v[192:195], v[0:3], 0
    s_waitcnt vmcnt(14)
    v_mfma_f32_16x16x32_bf16 v[184:187], v[192:195], v[4:7], 0
    v_max3_u32 v199, v176, v0, v4
    s_waitcnt vmcnt(13)
    v_mfma_f32_16x16x32_bf16 v[180:183], v[192:195], v[8:11], v[180:183]
    s_waitcnt vmcnt(12)
    v_mfma_f32_16x16x32_bf16 v[184:187], v[192:195], v[12:15], v[184:187]
    v_max3_u32 v199, v199, v8, v12
    s_waitcnt vmcnt(11)
    v_mfma_f32_16x16x32_bf16 v[180:183], v[192:195], v[16:19], v[180:183]
    v_add_f32_dpp v188, v188, v188 quad_perm:[1,0,3,2] row_mask:0xf bank_mask:0xf
    v_add_f32_dpp v189, v189, v189 quad_perm:[1,0,3,2] row_mask:0xf bank_mask:0xf
    s_waitcnt vmcnt(10)
    v_mfma_f32_16x16x32_bf16 v[184:187], v[192:195], v[20:23], v[184:187]
    v_max3_u32 v199, v199, v16, v20
    v_add_f32_dpp v190, v190, v190 quad_perm:[1,0,3,2] row_mask:0xf bank_mask:0xf
    v_add_f32_dpp v191, v191, v191 quad_perm:[1,0,3,2] row_mask:0xf bank_mask:0xf
    s_waitcnt vmcnt(9)
    v_mfma_f32_16x16x32_bf16 v[180:183], v[192:195], v[24:27], v[180:183]
    v_add_f32_dpp v188, v188, v188 quad_perm:[2,3,0,1] row_mask:0xf bank_mask:0xf
    v_add_f32_dpp v189, v189, v189 quad_perm:[2,3,0,1] row_mask:0xf bank_mask:0xf
    s_waitcnt vmcnt(8)
    v_mfma_f32_16x16x32_bf16 v[184:187], v[192:195], v[28:31], v[184:187]
    v_max3_u32 v199, v199, v24, v28
    v_add_f32_dpp v190, v190, v190 quad_perm:[2,3,0,1] row_mask:0xf bank_mask:0xf
    v_add_f32_dpp v191, v191, v191 quad_perm:[2,3,0,1] row_mask:0xf bank_mask:0xf
    s_waitcnt vmcnt(7)
    v_mfma_f32_16x16x32_bf16 v[180:183], v[192:195], v[32:35], v[180:183]
    v_add_f32_dpp v188, v188, v188 row_half_mirror row_mask:0xf bank_mask:0xf
    v_add_f32_dpp v189, v189, v189 row_half_mirror row_mask:0xf bank_mask:0xf
    s_waitcnt vmcnt(6)
    v_mfma_f32_16x16x32_bf16 v[184:187], v[192:195], v[36:39], v[184:187]
    v_max3_u32 v199, v199, v32, v36
    v_add_f32_dpp v190, v190, v190 row_half_mirror row_mask:0xf bank_mask:0xf
    v_add_f32_dpp v191, v191, v191 row_half_mirror row_mask:0xf bank_mask:0xf
    s_waitcnt vmcnt(5)
    v_mfma_f32_16x16x32_bf16 v[180:183], v[192:195], v[40:43], v[180:183]
    v_cvt_pk_bf16_f32 v188, v188, v189
    v_cvt_pk_bf16_f32 v189, v190, v191
    s_waitcnt vmcnt(4)
    v_mfma_f32_16x16x32_bf16 v[184:187], v[192:195], v[44:47], v[184:187]
    v_max3_u32 v199, v199, v40, v44
    ds_write_b64 v198, v[188:189] offset:256
    s_waitcnt vmcnt(3)
    v_mfma_f32_16x16x32_bf16 v[180:183], v[192:195], v[48:51], v[180:183]
    s_waitcnt vmcnt(2)
    v_mfma_f32_16x16x32_bf16 v[184:187], v[192:195], v[52:55], v[184:187]
    v_max3_u32 v199, v199, v48, v52
    s_waitcnt vmcnt(1)
    v_mfma_f32_16x16x32_bf16 v[180:183], v[192:195], v[56:59], v[180:183]
    s_waitcnt vmcnt(0)
    v_mfma_f32_16x16x32_bf16 v[184:187], v[192:195], v[60:63], v[184:187]
    v_max3_u32 v199, v199, v56, v60
    v_cmp_eq_u32 vcc, -1, v199
    s_cbranch_vccnz VK_R
VK_K:
    s_nop 2
    v_cvt_pk_bf16_f32 v180, v180, v181
    v_cvt_pk_bf16_f32 v181, v182, v183
    ds_write_b64 v197, v[180:181] offset:0
    v_cvt_pk_bf16_f32 v184, v184, v185
    v_cvt_pk_bf16_f32 v185, v186, v187
    ds_write_b64 v197, v[184:185] offset:544
    ds_write_b32 v248, v249 offset:64
    buffer_load_dword v250, v253, s[56:59], s86 offen sc1
    s_add_u32 s15, s82, 16384
    buffer_load_dwordx4 v[176:179], v254, s[56:59], s15 offen offset:0 sc1
    buffer_load_dwordx4 v[180:183], v254, s[56:59], s15 offen offset:1024 sc1
    buffer_load_dwordx4 v[184:187], v254, s[56:59], s15 offen offset:2048 sc1
    buffer_load_dwordx4 v[188:191], v254, s[56:59], s15 offen offset:3072 sc1
    s_add_u32 s15, s82, 20480
    buffer_load_dwordx4 v[192:195], v254, s[56:59], s15 offen offset:0 sc1
    buffer_load_dwordx4 v[196:199], v254, s[56:59], s15 offen offset:1024 sc1
    buffer_load_dwordx4 v[200:203], v254, s[56:59], s15 offen offset:2048 sc1
    buffer_load_dwordx4 v[204:207], v254, s[56:59], s15 offen offset:3072 sc1
    v_mov_b32 v251, 134944
    s_mov_b32 s14, 0
    s_nop 1
LPB0_P:
    ds_read_b128 v[240:243], v251
    s_add_u32 s14, s14, 1
    s_waitcnt lgkmcnt(0)
    v_min3_u32 v240, v240, v241, v242
    v_min_u32 v240, v240, v243
    s_nop 0
    v_readfirstlane_b32 s15, v240
    s_cmp_gt_u32 s14, 0x80000
    s_nop 0
    s_cselect_b32 s15, 2, s15
    s_cmp_lt_u32 s15, 2
    s_nop 0
    s_cbranch_scc1 LPB0_P
    s_mul_i32 s78, s84, 98304
    s_add_u32 s78, s78, 1048576
    s_lshl_b32 m0, s84, 12
    s_nop 0
    buffer_load_dwordx4 v252, s[64:67], s78 offen offset:0 lds
    s_add_u32 s79, s78, 7168
    buffer_load_dwordx4 v252, s[64:67], s79 offen offset:1024 lds
    s_add_u32 s80, s78, 14336
    buffer_load_dwordx4 v252, s[64:67], s80 offen offset:2048 lds
    s_add_u32 s81, s78, 21504
    buffer_load_dwordx4 v252, s[64:67], s81 offen offset:3072 lds
    s_mul_i32 s78, s84, 98304
    s_add_u32 s78, s78, 1081344
    s_lshl_b32 m0, s84, 12
    s_add_u32 m0, m0, 16384
    s_nop 0
    buffer_load_dwordx4 v252, s[64:67], s78 offen offset:0 lds
    s_add_u32 s79, s78, 7168
    buffer_load_dwordx4 v252, s[64:67], s79 offen offset:1024 lds
    s_add_u32 s80, s78, 14336
    buffer_load_dwordx4 v252, s[64:67], s80 offen offset:2048 lds
    s_add_u32 s81, s78, 21504
    buffer_load_dwordx4 v252, s[64:67], s81 offen offset:3072 lds
    s_mul_i32 s78, s84, 98304
    s_add_u32 s78, s78, 1114112
    s_lshl_b32 m0, s84, 12
    s_add_u32 m0, m0, 65536
    s_nop 0
    buffer_load_dwordx4 v252, s[64:67], s78 offen offset:0 lds
    s_add_u32 s79, s78, 7168
    buffer_load_dwordx4 v252, s[64:67], s79 offen offset:1024 lds
    s_add_u32 s80, s78, 14336
    buffer_load_dwordx4 v252, s[64:67], s80 offen offset:2048 lds
    s_add_u32 s81, s78, 21504
    buffer_load_dwordx4 v252, s[64:67], s81 offen offset:3072 lds
    v_mfma_f32_32x32x16_bf16 v[0:15], v[64:67], v[208:211], 0
    v_mfma_f32_32x32x16_bf16 v[16:31], v[64:67], v[212:215], 0
    v_mfma_f32_32x32x16_bf16 v[32:47], v[68:71], v[208:211], 0
    v_mfma_f32_32x32x16_bf16 v[48:63], v[68:71], v[212:215], 0
    v_mfma_f32_32x32x16_bf16 v[0:15], v[72:75], v[216:219], v[0:15]
    v_mfma_f32_32x32x16_bf16 v[16:31], v[72:75], v[220:223], v[16:31]
    v_mfma_f32_32x32x16_bf16 v[32:47], v[76:79], v[216:219], v[32:47]
    v_mfma_f32_32x32x16_bf16 v[48:63], v[76:79], v[220:223], v[48:63]
    v_mov_b32 v249, 3
    ds_write_b32 v248, v249
    ds_read_b64_tr_b16 v[64:65], v246 offset:16384
    ds_read_b64_tr_b16 v[66:67], v246 offset:17408
    ds_read_b64_tr_b16 v[68:69], v247 offset:16384
    ds_read_b64_tr_b16 v[70:71], v247 offset:17408
    ds_read_b64_tr_b16 v[72:73], v246 offset:18432
    ds_read_b64_tr_b16 v[74:75], v246 offset:19456
    ds_read_b64_tr_b16 v[76:77], v247 offset:18432
    ds_read_b64_tr_b16 v[78:79], v247 offset:19456
    v_mfma_f32_32x32x16_bf16 v[0:15], v[80:83], v[224:227], v[0:15]
    v_mfma_f32_32x32x16_bf16 v[16:31], v[80:83], v[228:231], v[16:31]
    v_mfma_f32_32x32x16_bf16 v[32:47], v[84:87], v[224:227], v[32:47]
    v_mfma_f32_32x32x16_bf16 v[48:63], v[84:87], v[228:231], v[48:63]
    v_mfma_f32_32x32x16_bf16 v[0:15], v[88:91], v[232:235], v[0:15]
    v_mfma_f32_32x32x16_bf16 v[16:31], v[88:91], v[236:239], v[16:31]
    v_mfma_f32_32x32x16_bf16 v[32:47], v[92:95], v[232:235], v[32:47]
    v_mfma_f32_32x32x16_bf16 v[48:63], v[92:95], v[236:239], v[48:63]
    s_waitcnt vmcnt(20)
    s_mov_b32 s14, 0
    s_nop 9
LA04_P:
    v_cmp_ne_u32 vcc, s3, v250
    s_nop 1
    s_and_b32 vcc_lo, vcc_lo, 0xff
    s_cmp_eq_u32 vcc_lo, 0
    s_nop 0
    s_cbranch_scc1 LA04_G
    s_add_u32 s14, s14, 1
    s_cmp_gt_u32 s14, 0x8000
    s_cbranch_scc1 LA04_G
    s_sleep 8
    buffer_load_dword v250, v253, s[56:59], s86 offen sc1
    s_waitcnt vmcnt(0)
    s_branch LA04_P
LA04_G:
    s_add_u32 s15, s82, 8192
    buffer_load_dwordx4 v[208:211], v254, s[56:59], s15 offen offset:0 sc1
    buffer_load_dwordx4 v[212:215], v254, s[56:59], s15 offen offset:1024 sc1
    buffer_load_dwordx4 v[216:219], v254, s[56:59], s15 offen offset:2048 sc1
    buffer_load_dwordx4 v[220:223], v254, s[56:59], s15 offen offset:3072 sc1
    s_add_u32 s15, s82, 12288
    buffer_load_dwordx4 v[224:227], v254, s[56:59], s15 offen offset:0 sc1
    buffer_load_dwordx4 v[228:231], v254, s[56:59], s15 offen offset:1024 sc1
    buffer_load_dwordx4 v[232:235], v254, s[56:59], s15 offen offset:2048 sc1
    buffer_load_dwordx4 v[236:239], v254, s[56:59], s15 offen offset:3072 sc1
    buffer_load_dword v250, v253, s[56:59], s86 offen sc1
    s_waitcnt vmcnt(25)
    v_mfma_f32_32x32x16_bf16 v[0:15], v[96:99], v[176:179], v[0:15]
    v_mfma_f32_32x32x16_bf16 v[16:31], v[96:99], v[180:183], v[16:31]
    v_mfma_f32_32x32x16_bf16 v[32:47], v[100:103], v[176:179], v[32:47]
    v_mfma_f32_32x32x16_bf16 v[48:63], v[100:103], v[180:183], v[48:63]
    v_mfma_f32_32x32x16_bf16 v[0:15], v[104:107], v[184:187], v[0:15]
    v_mfma_f32_32x32x16_bf16 v[16:31], v[104:107], v[188:191], v[16:31]
    v_mfma_f32_32x32x16_bf16 v[32:47], v[108:111], v[184:187], v[32:47]
    v_mfma_f32_32x32x16_bf16 v[48:63], v[108:111], v[188:191], v[48:63]
    s_add_u32 s15, s82, 24576
    buffer_load_dwordx4 v[176:179], v254, s[56:59], s15 offen offset:0 sc1
    buffer_load_dwordx4 v[180:183], v254, s[56:59], s15 offen offset:1024 sc1
    buffer_load_dwordx4 v[184:187], v254, s[56:59], s15 offen offset:2048 sc1
    buffer_load_dwordx4 v[188:191], v254, s[56:59], s15 offen offset:3072 sc1
    s_waitcnt vmcnt(25)
    v_mfma_f32_32x32x16_bf16 v[0:15], v[112:115], v[192:195], v[0:15]
    v_mfma_f32_32x32x16_bf16 v[16:31], v[112:115], v[196:199], v[16:31]
    v_mfma_f32_32x32x16_bf16 v[32:47], v[116:119], v[192:195], v[32:47]
    v_mfma_f32_32x32x16_bf16 v[48:63], v[116:119], v[196:199], v[48:63]
    v_mfma_f32_32x32x16_bf16 v[0:15], v[120:123], v[200:203], v[0:15]
    v_mfma_f32_32x32x16_bf16 v[16:31], v[120:123], v[204:207], v[16:31]
    v_mfma_f32_32x32x16_bf16 v[32:47], v[124:127], v[200:203], v[32:47]
    v_mfma_f32_32x32x16_bf16 v[48:63], v[124:127], v[204:207], v[48:63]
    s_add_u32 s15, s82, 28672
    buffer_load_dwordx4 v[192:195], v254, s[56:59], s15 offen offset:0 sc1
    buffer_load_dwordx4 v[196:199], v254, s[56:59], s15 offen offset:1024 sc1
    buffer_load_dwordx4 v[200:203], v254, s[56:59], s15 offen offset:2048 sc1
    buffer_load_dwordx4 v[204:207], v254, s[56:59], s15 offen offset:3072 sc1
    s_waitcnt vmcnt(17)
    ds_read_b64_tr_b16 v[80:81], v244 offset:0
    ds_read_b64_tr_b16 v[82:83], v244 offset:1024
    ds_read_b64_tr_b16 v[84:85], v245 offset:0
    ds_read_b64_tr_b16 v[86:87], v245 offset:1024
    ds_read_b64_tr_b16 v[88:89], v244 offset:2048
    ds_read_b64_tr_b16 v[90:91], v244 offset:3072
    ds_read_b64_tr_b16 v[92:93], v245 offset:2048
    ds_read_b64_tr_b16 v[94:95], v245 offset:3072
    ds_read_b64_tr_b16 v[96:97], v244 offset:16384
    ds_read_b64_tr_b16 v[98:99], v244 offset:17408
    ds_read_b64_tr_b16 v[100:101], v245 offset:16384
    ds_read_b64_tr_b16 v[102:103], v245 offset:17408
    ds_read_b64_tr_b16 v[104:105], v244 offset:18432
    ds_read_b64_tr_b16 v[106:107], v244 offset:19456
    ds_read_b64_tr_b16 v[108:109], v245 offset:18432
    ds_read_b64_tr_b16 v[110:111], v245 offset:19456
    ds_read_b64_tr_b16 v[112:113], v246 offset:0
    ds_read_b64_tr_b16 v[114:115], v246 offset:1024
    ds_read_b64_tr_b16 v[116:117], v247 offset:0
    ds_read_b64_tr_b16 v[118:119], v247 offset:1024
    ds_read_b64_tr_b16 v[120:121], v246 offset:2048
    ds_read_b64_tr_b16 v[122:123], v246 offset:3072
    ds_read_b64_tr_b16 v[124:125], v247 offset:2048
    ds_read_b64_tr_b16 v[126:127], v247 offset:3072
    s_waitcnt vmcnt(13)
    v_mfma_f32_32x32x16_bf16 v[0:15], v[128:131], v[208:211], v[0:15]
    v_mfma_f32_32x32x16_bf16 v[16:31], v[128:131], v[212:215], v[16:31]
    v_mfma_f32_32x32x16_bf16 v[32:47], v[132:135], v[208:211], v[32:47]
    v_mfma_f32_32x32x16_bf16 v[48:63], v[132:135], v[212:215], v[48:63]
    v_mfma_f32_32x32x16_bf16 v[0:15], v[136:139], v[216:219], v[0:15]
    v_mfma_f32_32x32x16_bf16 v[16:31], v[136:139], v[220:223], v[16:31]
    v_mfma_f32_32x32x16_bf16 v[32:47], v[140:143], v[216:219], v[32:47]
    v_mfma_f32_32x32x16_bf16 v[48:63], v[140:143], v[220:223], v[48:63]
    s_waitcnt vmcnt(8)
    s_mov_b32 s14, 0
    s_nop 9
LA08_P:
    v_cmp_ne_u32 vcc, s3, v250
    s_nop 1
    s_and_b32 vcc_lo, vcc_lo, 0x3f00
    s_cmp_eq_u32 vcc_lo, 0
    s_nop 0
    s_cbranch_scc1 LA08_G
    s_add_u32 s14, s14, 1
    s_cmp_gt_u32 s14, 0x8000
    s_cbranch_scc1 LA08_G
    s_sleep 8
    buffer_load_dword v250, v253, s[56:59], s86 offen sc1
    s_waitcnt vmcnt(0)
    s_branch LA08_P
LA08_G:
    s_add_u32 s15, s83, 131072
    buffer_load_dwordx4 v[208:211], v254, s[56:59], s15 offen offset:0 sc1
    buffer_load_dwordx4 v[212:215], v254, s[56:59], s15 offen offset:1024 sc1
    buffer_load_dwordx4 v[216:219], v254, s[56:59], s15 offen offset:2048 sc1
    buffer_load_dwordx4 v[220:223], v254, s[56:59], s15 offen offset:3072 sc1
    v_mfma_f32_32x32x16_bf16 v[0:15], v[144:147], v[224:227], v[0:15]
    v_mfma_f32_32x32x16_bf16 v[16:31], v[144:147], v[228:231], v[16:31]
    v_mfma_f32_32x32x16_bf16 v[32:47], v[148:151], v[224:227], v[32:47]
    v_mfma_f32_32x32x16_bf16 v[48:63], v[148:151], v[228:231], v[48:63]
    v_mfma_f32_32x32x16_bf16 v[0:15], v[152:155], v[232:235], v[0:15]
    v_mfma_f32_32x32x16_bf16 v[16:31], v[152:155], v[236:239], v[16:31]
    v_mfma_f32_32x32x16_bf16 v[32:47], v[156:159], v[232:235], v[32:47]
    v_mfma_f32_32x32x16_bf16 v[48:63], v[156:159], v[236:239], v[48:63]
    s_add_u32 s15, s83, 135168
    buffer_load_dwordx4 v[224:227], v254, s[56:59], s15 offen offset:0 sc1
    buffer_load_dwordx4 v[228:231], v254, s[56:59], s15 offen offset:1024 sc1
    buffer_load_dwordx4 v[232:235], v254, s[56:59], s15 offen offset:2048 sc1
    buffer_load_dwordx4 v[236:239], v254, s[56:59], s15 offen offset:3072 sc1
    s_waitcnt vmcnt(12)
    v_mfma_f32_32x32x16_bf16 v[0:15], v[160:163], v[176:179], v[0:15]
    v_mfma_f32_32x32x16_bf16 v[16:31], v[160:163], v[180:183], v[16:31]
    v_mfma_f32_32x32x16_bf16 v[32:47], v[164:167], v[176:179], v[32:47]
    v_mfma_f32_32x32x16_bf16 v[48:63], v[164:167], v[180:183], v[48:63]
    v_mfma_f32_32x32x16_bf16 v[0:15], v[168:171], v[184:187], v[0:15]
    v_mfma_f32_32x32x16_bf16 v[16:31], v[168:171], v[188:191], v[16:31]
    v_mfma_f32_32x32x16_bf16 v[32:47], v[172:175], v[184:187], v[32:47]
    v_mfma_f32_32x32x16_bf16 v[48:63], v[172:175], v[188:191], v[48:63]
    s_add_u32 s15, s83, 139264
    buffer_load_dwordx4 v[176:179], v254, s[56:59], s15 offen offset:0 sc1
    buffer_load_dwordx4 v[180:183], v254, s[56:59], s15 offen offset:1024 sc1
    buffer_load_dwordx4 v[184:187], v254, s[56:59], s15 offen offset:2048 sc1
    buffer_load_dwordx4 v[188:191], v254, s[56:59], s15 offen offset:3072 sc1
    v_lshrrev_b32 v240, 3, v255
    v_and_b32 v241, 7, v255
    v_lshlrev_b32 v240, 10, v240
    v_lshl_add_u32 v240, v241, 4, v240
    s_lshl_b32 s6, s12, 3
    s_add_u32 s6, s6, s4
    s_lshl_b32 s6, s6, 13
    s_lshl_b32 s7, s13, 7
    s_add_u32 s6, s6, s7
    buffer_load_dwordx4 v[244:247], v240, s[40:43], s6 offen
    s_waitcnt vmcnt(13)
    s_waitcnt lgkmcnt(14)
    v_mfma_f32_32x32x16_bf16 v[0:15], v[64:67], v[192:195], v[0:15]
    v_mfma_f32_32x32x16_bf16 v[16:31], v[64:67], v[196:199], v[16:31]
    v_mfma_f32_32x32x16_bf16 v[32:47], v[68:71], v[192:195], v[32:47]
    v_mfma_f32_32x32x16_bf16 v[48:63], v[68:71], v[196:199], v[48:63]
    v_mfma_f32_32x32x16_bf16 v[0:15], v[72:75], v[200:203], v[0:15]
    v_mfma_f32_32x32x16_bf16 v[16:31], v[72:75], v[204:207], v[16:31]
    v_mfma_f32_32x32x16_bf16 v[32:47], v[76:79], v[200:203], v[32:47]
    v_mfma_f32_32x32x16_bf16 v[48:63], v[76:79], v[204:207], v[48:63]
    s_waitcnt vmcnt(9)
    v_mfma_f32_32x32x16_bf16 v[0:15], v[80:83], v[208:211], v[0:15]
    v_mfma_f32_32x32x16_bf16 v[16:31], v[80:83], v[212:215], v[16:31]
    v_mfma_f32_32x32x16_bf16 v[32:47], v[84:87], v[208:211], v[32:47]
    v_mfma_f32_32x32x16_bf16 v[48:63], v[84:87], v[212:215], v[48:63]
    v_mfma_f32_32x32x16_bf16 v[0:15], v[88:91], v[216:219], v[0:15]
    v_mfma_f32_32x32x16_bf16 v[16:31], v[88:91], v[220:223], v[16:31]
    v_mfma_f32_32x32x16_bf16 v[32:47], v[92:95], v[216:219], v[32:47]
    v_mfma_f32_32x32x16_bf16 v[48:63], v[92:95], v[220:223], v[48:63]
    s_lshl_b32 s14, s85, 1
    v_and_b32 v64, 31, v255
    v_lshrrev_b32 v65, 5, v255
    v_xor_b32 v65, v65, v255
    v_and_b32 v65, 7, v65
    v_lshlrev_b32 v65, 4, v65
    v_lshl_add_u32 v64, v64, 7, v65
    v_add_u32 v64, s14, v64
    v_xor_b32 v65, 32, v64
    v_xor_b32 v66, 64, v64
    v_xor_b32 v67, 96, v64
    v_xor_b32 v68, 16, v64
    v_add_u32 v68, 65536, v68
    v_xor_b32 v69, 16, v65
    v_add_u32 v69, 65536, v69
    v_xor_b32 v70, 16, v66
    v_add_u32 v70, 65536, v70
    v_xor_b32 v71, 16, v67
    v_add_u32 v71, 65536, v71
    s_waitcnt vmcnt(5)
    s_waitcnt lgkmcnt(8)
    v_mfma_f32_32x32x16_bf16 v[0:15], v[96:99], v[224:227], v[0:15]
    v_mfma_f32_32x32x16_bf16 v[16:31], v[96:99], v[228:231], v[16:31]
    v_mfma_f32_32x32x16_bf16 v[32:47], v[100:103], v[224:227], v[32:47]
    v_mfma_f32_32x32x16_bf16 v[48:63], v[100:103], v[228:231], v[48:63]
    v_mfma_f32_32x32x16_bf16 v[0:15], v[104:107], v[232:235], v[0:15]
    v_mfma_f32_32x32x16_bf16 v[16:31], v[104:107], v[236:239], v[16:31]
    v_mfma_f32_32x32x16_bf16 v[32:47], v[108:111], v[232:235], v[32:47]
    v_mfma_f32_32x32x16_bf16 v[48:63], v[108:111], v[236:239], v[48:63]
    s_waitcnt vmcnt(1)
    s_waitcnt lgkmcnt(0)
    v_mfma_f32_32x32x16_bf16 v[0:15], v[112:115], v[176:179], v[0:15]
    v_mfma_f32_32x32x16_bf16 v[0:15], v[120:123], v[184:187], v[0:15]
    v_mfma_f32_32x32x16_bf16 v[16:31], v[112:115], v[180:183], v[16:31]
    v_mfma_f32_32x32x16_bf16 v[16:31], v[120:123], v[188:191], v[16:31]
    s_nop 9
    ds_write_b128 v64, v[0:3] offset:0
    ds_write_b128 v65, v[4:7] offset:0
    ds_write_b128 v66, v[8:11] offset:0
    ds_write_b128 v67, v[12:15] offset:0
    v_mfma_f32_32x32x16_bf16 v[32:47], v[116:119], v[176:179], v[32:47]
    v_mfma_f32_32x32x16_bf16 v[32:47], v[124:127], v[184:187], v[32:47]
    ds_write_b128 v64, v[16:19] offset:16384
    ds_write_b128 v65, v[20:23] offset:16384
    ds_write_b128 v66, v[24:27] offset:16384
    ds_write_b128 v67, v[28:31] offset:16384
    v_mfma_f32_32x32x16_bf16 v[48:63], v[116:119], v[180:183], v[48:63]
    v_mfma_f32_32x32x16_bf16 v[48:63], v[124:127], v[188:191], v[48:63]
    s_nop 5
    ds_write_b128 v68, v[32:35] offset:0
    ds_write_b128 v69, v[36:39] offset:0
    ds_write_b128 v70, v[40:43] offset:0
    ds_write_b128 v71, v[44:47] offset:0
    s_nop 1
    ds_write_b128 v68, v[48:51] offset:16384
    ds_write_b128 v69, v[52:55] offset:16384
    ds_write_b128 v70, v[56:59] offset:16384
    ds_write_b128 v71, v[60:63] offset:16384
    s_branch F_START
LX_START:
    s_mul_i32 s78, s84, 262144
    s_lshl_b32 m0, s84, 12
    s_add_u32 m0, m0, 81920
    s_nop 0
    buffer_load_dwordx4 v252, s[64:67], s78 offen offset:0 lds
    s_add_u32 s79, s78, 7168
    buffer_load_dwordx4 v252, s[64:67], s79 offen offset:1024 lds
    s_add_u32 s80, s78, 14336
    buffer_load_dwordx4 v252, s[64:67], s80 offen offset:2048 lds
    s_add_u32 s81, s78, 21504
    buffer_load_dwordx4 v252, s[64:67], s81 offen offset:3072 lds
    s_mul_i32 s78, s84, 262144
    s_add_u32 s78, s78, 32768
    s_lshl_b32 m0, s84, 12
    s_add_u32 m0, m0, 98304
    s_nop 0
    buffer_load_dwordx4 v252, s[64:67], s78 offen offset:0 lds
    s_add_u32 s79, s78, 7168
    buffer_load_dwordx4 v252, s[64:67], s79 offen offset:1024 lds
    s_add_u32 s80, s78, 14336
    buffer_load_dwordx4 v252, s[64:67], s80 offen offset:2048 lds
    s_add_u32 s81, s78, 21504
    buffer_load_dwordx4 v252, s[64:67], s81 offen offset:3072 lds
    s_lshl_b32 s86, s12, 3
    s_add_u32 s86, s86, s84
    s_lshl_b32 s86, s86, 7
    s_add_u32 s86, s86, 0xc90000
    s_mul_i32 s87, s12, 245760
    s_lshl_b32 s82, s84, 15
    s_add_u32 s82, s82, s87
    s_mul_i32 s83, s84, 12288
    s_add_u32 s83, s83, s87
    s_waitcnt vmcnt(8)
    ds_write_b32 v248, v249
    s_waitcnt vmcnt(4)
    ds_read_b64_tr_b16 v[64:65], v246 offset:16384
    ds_read_b64_tr_b16 v[66:67], v246 offset:17408
    ds_read_b64_tr_b16 v[68:69], v247 offset:16384
    ds_read_b64_tr_b16 v[70:71], v247 offset:17408
    ds_read_b64_tr_b16 v[72:73], v246 offset:18432
    ds_read_b64_tr_b16 v[74:75], v246 offset:19456
    ds_read_b64_tr_b16 v[76:77], v247 offset:18432
    ds_read_b64_tr_b16 v[78:79], v247 offset:19456
    s_waitcnt lgkmcnt(0)
    s_mul_i32 s78, s84, 262144
    s_add_u32 s78, s78, 131072
    s_lshl_b32 m0, s84, 12
    s_add_u32 m0, m0, 81920
    s_nop 0
    buffer_load_dwordx4 v252, s[64:67], s78 offen offset:0 lds
    s_add_u32 s79, s78, 7168
    buffer_load_dwordx4 v252, s[64:67], s79 offen offset:1024 lds
    s_add_u32 s80, s78, 14336
    buffer_load_dwordx4 v252, s[64:67], s80 offen offset:2048 lds
    s_add_u32 s81, s78, 21504
    buffer_load_dwordx4 v252, s[64:67], s81 offen offset:3072 lds
    s_waitcnt vmcnt(4)
    ds_read_b64_tr_b16 v[80:81], v246 offset:32768
    ds_read_b64_tr_b16 v[82:83], v246 offset:33792
    ds_read_b64_tr_b16 v[84:85], v247 offset:32768
    ds_read_b64_tr_b16 v[86:87], v247 offset:33792
    ds_read_b64_tr_b16 v[88:89], v246 offset:34816
    ds_read_b64_tr_b16 v[90:91], v246 offset:35840
    ds_read_b64_tr_b16 v[92:93], v247 offset:34816
    ds_read_b64_tr_b16 v[94:95], v247 offset:35840
    s_waitcnt lgkmcnt(0)
    s_mul_i32 s78, s84, 262144
    s_add_u32 s78, s78, 163840
    s_lshl_b32 m0, s84, 12
    s_add_u32 m0, m0, 98304
    s_nop 0
    buffer_load_dwordx4 v252, s[64:67], s78 offen offset:0 lds
    s_add_u32 s79, s78, 7168
    buffer_load_dwordx4 v252, s[64:67], s79 offen offset:1024 lds
    s_add_u32 s80, s78, 14336
    buffer_load_dwordx4 v252, s[64:67], s80 offen offset:2048 lds
    s_add_u32 s81, s78, 21504
    buffer_load_dwordx4 v252, s[64:67], s81 offen offset:3072 lds
    s_waitcnt vmcnt(4)
    ds_read_b64_tr_b16 v[96:97], v246 offset:16384
    ds_read_b64_tr_b16 v[98:99], v246 offset:17408
    ds_read_b64_tr_b16 v[100:101], v247 offset:16384
    ds_read_b64_tr_b16 v[102:103], v247 offset:17408
    ds_read_b64_tr_b16 v[104:105], v246 offset:18432
    ds_read_b64_tr_b16 v[106:107], v246 offset:19456
    ds_read_b64_tr_b16 v[108:109], v247 offset:18432
    ds_read_b64_tr_b16 v[110:111], v247 offset:19456
    s_waitcnt lgkmcnt(0)
    s_mul_i32 s78, s84, 262144
    s_add_u32 s78, s78, 65536
    s_lshl_b32 m0, s84, 12
    s_add_u32 m0, m0, 81920
    s_nop 0
    buffer_load_dwordx4 v252, s[64:67], s78 offen offset:0 lds
    s_add_u32 s79, s78, 7168
    buffer_load_dwordx4 v252, s[64:67], s79 offen offset:1024 lds
    s_add_u32 s80, s78, 14336
    buffer_load_dwordx4 v252, s[64:67], s80 offen offset:2048 lds
    s_add_u32 s81, s78, 21504
    buffer_load_dwordx4 v252, s[64:67], s81 offen offset:3072 lds
    s_waitcnt vmcnt(4)
    ds_read_b64_tr_b16 v[112:113], v246 offset:32768
    ds_read_b64_tr_b16 v[114:115], v246 offset:33792
    ds_read_b64_tr_b16 v[116:117], v247 offset:32768
    ds_read_b64_tr_b16 v[118:119], v247 offset:33792
    ds_read_b64_tr_b16 v[120:121], v246 offset:34816
    ds_read_b64_tr_b16 v[122:123], v246 offset:35840
    ds_read_b64_tr_b16 v[124:125], v247 offset:34816
    ds_read_b64_tr_b16 v[126:127], v247 offset:35840
    s_waitcnt lgkmcnt(0)
    s_mul_i32 s78, s84, 262144
    s_add_u32 s78, s78, 98304
    s_lshl_b32 m0, s84, 12
    s_add_u32 m0, m0, 98304
    s_nop 0
    buffer_load_dwordx4 v252, s[64:67], s78 offen offset:0 lds
    s_add_u32 s79, s78, 7168
    buffer_load_dwordx4 v252, s[64:67], s79 offen offset:1024 lds
    s_add_u32 s80, s78, 14336
    buffer_load_dwordx4 v252, s[64:67], s80 offen offset:2048 lds
    s_add_u32 s81, s78, 21504
    buffer_load_dwordx4 v252, s[64:67], s81 offen offset:3072 lds
    s_waitcnt vmcnt(4)
    ds_read_b64_tr_b16 v[128:129], v246 offset:16384
    ds_read_b64_tr_b16 v[130:131], v246 offset:17408
    ds_read_b64_tr_b16 v[132:133], v247 offset:16384
    ds_read_b64_tr_b16 v[134:135], v247 offset:17408
    ds_read_b64_tr_b16 v[136:137], v246 offset:18432
    ds_read_b64_tr_b16 v[138:139], v246 offset:19456
    ds_read_b64_tr_b16 v[140:141], v247 offset:18432
    ds_read_b64_tr_b16 v[142:143], v247 offset:19456
    s_waitcnt lgkmcnt(0)
    s_mul_i32 s78, s84, 262144
    s_add_u32 s78, s78, 196608
    s_lshl_b32 m0, s84, 12
    s_add_u32 m0, m0, 81920
    s_nop 0
    buffer_load_dwordx4 v252, s[64:67], s78 offen offset:0 lds
    s_add_u32 s79, s78, 7168
    buffer_load_dwordx4 v252, s[64:67], s79 offen offset:1024 lds
    s_add_u32 s80, s78, 14336
    buffer_load_dwordx4 v252, s[64:67], s80 offen offset:2048 lds
    s_add_u32 s81, s78, 21504
    buffer_load_dwordx4 v252, s[64:67], s81 offen offset:3072 lds
    s_waitcnt vmcnt(4)
    ds_read_b64_tr_b16 v[144:145], v246 offset:32768
    ds_read_b64_tr_b16 v[146:147], v246 offset:33792
    ds_read_b64_tr_b16 v[148:149], v247 offset:32768
    ds_read_b64_tr_b16 v[150:151], v247 offset:33792
    ds_read_b64_tr_b16 v[152:153], v246 offset:34816
    ds_read_b64_tr_b16 v[154:155], v246 offset:35840
    ds_read_b64_tr_b16 v[156:157], v247 offset:34816
    ds_read_b64_tr_b16 v[158:159], v247 offset:35840
    s_waitcnt lgkmcnt(0)
    s_lshl_b32 s78, s84, 17
    s_add_u32 s78, s78, 65536
    s_lshl_b32 m0, s84, 12
    s_add_u32 m0, m0, 98304
    s_nop 0
    buffer_load_dwordx4 v252, s[68:71], s78 offen offset:0 lds
    s_add_u32 s79, s78, 7168
    buffer_load_dwordx4 v252, s[68:71], s79 offen offset:1024 lds
    s_add_u32 s80, s78, 14336
    buffer_load_dwordx4 v252, s[68:71], s80 offen offset:2048 lds
    s_add_u32 s81, s78, 21504
    buffer_load_dwordx4 v252, s[68:71], s81 offen offset:3072 lds
    s_waitcnt vmcnt(4)
    ds_read_b64_tr_b16 v[160:161], v246 offset:16384
    ds_read_b64_tr_b16 v[162:163], v246 offset:17408
    ds_read_b64_tr_b16 v[164:165], v247 offset:16384
    ds_read_b64_tr_b16 v[166:167], v247 offset:17408
    ds_read_b64_tr_b16 v[168:169], v246 offset:18432
    ds_read_b64_tr_b16 v[170:171], v246 offset:19456
    ds_read_b64_tr_b16 v[172:173], v247 offset:18432
    ds_read_b64_tr_b16 v[174:175], v247 offset:19456
    s_waitcnt lgkmcnt(0)
    s_mul_i32 s78, s84, 262144
    s_add_u32 s78, s78, 229376
    s_lshl_b32 m0, s84, 12
    s_add_u32 m0, m0, 81920
    s_nop 0
    buffer_load_dwordx4 v252, s[64:67], s78 offen offset:0 lds
    s_add_u32 s79, s78, 7168
    buffer_load_dwordx4 v252, s[64:67], s79 offen offset:1024 lds
    s_add_u32 s80, s78, 14336
    buffer_load_dwordx4 v252, s[64:67], s80 offen offset:2048 lds
    s_add_u32 s81, s78, 21504
    buffer_load_dwordx4 v252, s[64:67], s81 offen offset:3072 lds
    v_mov_b32 v251, 134992
    s_mov_b32 s14, 0
    s_nop 1
LXK_P:
    ds_read_b128 v[240:243], v251
    s_add_u32 s14, s14, 1
    s_waitcnt lgkmcnt(0)
    v_min3_u32 v240, v240, v241, v242
    v_min_u32 v240, v240, v243
    s_nop 0
    v_readfirstlane_b32 s15, v240
    s_cmp_gt_u32 s14, 0x80000
    s_nop 0
    s_cselect_b32 s15, 1, s15
    s_cmp_lt_u32 s15, 1
    s_nop 0
    s_cbranch_scc1 LXK_P
    s_lshl_b32 s78, s84, 17
    s_lshl_b32 m0, s84, 12
    s_add_u32 m0, m0, 32768
    s_nop 0
    buffer_load_dwordx4 v252, s[68:71], s78 offen offset:0 lds
    s_add_u32 s79, s78, 7168
    buffer_load_dwordx4 v252, s[68:71], s79 offen offset:1024 lds
    s_add_u32 s80, s78, 14336
    buffer_load_dwordx4 v252, s[68:71], s80 offen offset:2048 lds
    s_add_u32 s81, s78, 21504
    buffer_load_dwordx4 v252, s[68:71], s81 offen offset:3072 lds
    buffer_load_dword v250, v253, s[56:59], s86 offen sc1
    s_lshl_b32 s78, s84, 17
    s_add_u32 s78, s78, 32768
    s_lshl_b32 m0, s84, 12
    s_add_u32 m0, m0, 49152
    s_nop 0
    buffer_load_dwordx4 v252, s[68:71], s78 offen offset:0 lds
    s_add_u32 s79, s78, 7168
    buffer_load_dwordx4 v252, s[68:71], s79 offen offset:1024 lds
    s_add_u32 s80, s78, 14336
    buffer_load_dwordx4 v252, s[68:71], s80 offen offset:2048 lds
    s_add_u32 s81, s78, 21504
    buffer_load_dwordx4 v252, s[68:71], s81 offen offset:3072 lds
    s_lshl_b32 s78, s84, 17
    s_add_u32 s78, s78, 98304
    s_lshl_b32 m0, s84, 12
    s_add_u32 m0, m0, 114688
    s_nop 0
    buffer_load_dwordx4 v252, s[68:71], s78 offen offset:0 lds
    s_add_u32 s79, s78, 7168
    buffer_load_dwordx4 v252, s[68:71], s79 offen offset:1024 lds
    s_add_u32 s80, s78, 14336
    buffer_load_dwordx4 v252, s[68:71], s80 offen offset:2048 lds
    s_add_u32 s81, s78, 21504
    buffer_load_dwordx4 v252, s[68:71], s81 offen offset:3072 lds
    s_waitcnt vmcnt(8)
    s_mov_b32 s14, 0
LA10_P:
    v_cmp_ne_u32 vcc, s3, v250
    s_nop 1
    s_and_b32 vcc_lo, vcc_lo, 0xf
    s_cmp_eq_u32 vcc_lo, 0
    s_nop 0
    s_cbranch_scc1 LA10_G
    s_add_u32 s14, s14, 1
    s_cmp_gt_u32 s14, 0x8000
    s_cbranch_scc1 LA10_G
    s_sleep 8
    buffer_load_dword v250, v253, s[56:59], s86 offen sc1
    s_waitcnt vmcnt(0)
    s_branch LA10_P
LA10_G:
    s_add_u32 s15, s82, 0
    buffer_load_dwordx4 v[208:211], v254, s[56:59], s15 offen offset:0 sc1
    buffer_load_dwordx4 v[212:215], v254, s[56:59], s15 offen offset:1024 sc1
    buffer_load_dwordx4 v[216:219], v254, s[56:59], s15 offen offset:2048 sc1
    buffer_load_dwordx4 v[220:223], v254, s[56:59], s15 offen offset:3072 sc1
    s_add_u32 s15, s82, 4096
    buffer_load_dwordx4 v[224:227], v254, s[56:59], s15 offen offset:0 sc1
    buffer_load_dwordx4 v[228:231], v254, s[56:59], s15 offen offset:1024 sc1
    buffer_load_dwordx4 v[232:235], v254, s[56:59], s15 offen offset:2048 sc1
    buffer_load_dwordx4 v[236:239], v254, s[56:59], s15 offen offset:3072 sc1
    s_add_u32 s15, s82, 16384
    buffer_load_dwordx4 v[176:179], v254, s[56:59], s15 offen offset:0 sc1
    buffer_load_dwordx4 v[180:183], v254, s[56:59], s15 offen offset:1024 sc1
    buffer_load_dwordx4 v[184:187], v254, s[56:59], s15 offen offset:2048 sc1
    buffer_load_dwordx4 v[188:191], v254, s[56:59], s15 offen offset:3072 sc1
    s_add_u32 s15, s82, 20480
    buffer_load_dwordx4 v[192:195], v254, s[56:59], s15 offen offset:0 sc1
    buffer_load_dwordx4 v[196:199], v254, s[56:59], s15 offen offset:1024 sc1
    buffer_load_dwordx4 v[200:203], v254, s[56:59], s15 offen offset:2048 sc1
    buffer_load_dwordx4 v[204:207], v254, s[56:59], s15 offen offset:3072 sc1
    v_mov_b32 v251, 134944
    s_mov_b32 s14, 0
    s_nop 1
LXH_P:
    ds_read_b128 v[240:243], v251
    s_add_u32 s14, s14, 1
    s_waitcnt lgkmcnt(0)
    v_min3_u32 v240, v240, v241, v242
    v_min_u32 v240, v240, v243
    s_nop 0
    v_readfirstlane_b32 s15, v240
    s_cmp_gt_u32 s14, 0x80000
    s_nop 0
    s_cselect_b32 s15, 2, s15
    s_cmp_lt_u32 s15, 2
    s_nop 0
    s_cbranch_scc1 LXH_P
    buffer_load_dword v250, v253, s[56:59], s86 offen sc1
    v_mov_b32 v251, 134944
    s_mov_b32 s14, 0
    s_nop 1
LPB1_P:
    ds_read_b128 v[240:243], v251
    s_add_u32 s14, s14, 1
    s_waitcnt lgkmcnt(0)
    v_min3_u32 v240, v240, v241, v242
    v_min_u32 v240, v240, v243
    s_nop 0
    v_readfirstlane_b32 s15, v240
    s_cmp_gt_u32 s14, 0x80000
    s_nop 0
    s_cselect_b32 s15, 2, s15
    s_cmp_lt_u32 s15, 2
    s_nop 0
    s_cbranch_scc1 LPB1_P
    s_mul_i32 s78, s84, 98304
    s_add_u32 s78, s78, 1048576
    s_lshl_b32 m0, s84, 12
    s_nop 0
    buffer_load_dwordx4 v252, s[64:67], s78 offen offset:0 lds
    s_add_u32 s79, s78, 7168
    buffer_load_dwordx4 v252, s[64:67], s79 offen offset:1024 lds
    s_add_u32 s80, s78, 14336
    buffer_load_dwordx4 v252, s[64:67], s80 offen offset:2048 lds
    s_add_u32 s81, s78, 21504
    buffer_load_dwordx4 v252, s[64:67], s81 offen offset:3072 lds
    s_mul_i32 s78, s84, 98304
    s_add_u32 s78, s78, 1081344
    s_lshl_b32 m0, s84, 12
    s_add_u32 m0, m0, 16384
    s_nop 0
    buffer_load_dwordx4 v252, s[64:67], s78 offen offset:0 lds
    s_add_u32 s79, s78, 7168
    buffer_load_dwordx4 v252, s[64:67], s79 offen offset:1024 lds
    s_add_u32 s80, s78, 14336
    buffer_load_dwordx4 v252, s[64:67], s80 offen offset:2048 lds
    s_add_u32 s81, s78, 21504
    buffer_load_dwordx4 v252, s[64:67], s81 offen offset:3072 lds
    s_mul_i32 s78, s84, 98304
    s_add_u32 s78, s78, 1114112
    s_lshl_b32 m0, s84, 12
    s_add_u32 m0, m0, 65536
    s_nop 0
    buffer_load_dwordx4 v252, s[64:67], s78 offen offset:0 lds
    s_add_u32 s79, s78, 7168
    buffer_load_dwordx4 v252, s[64:67], s79 offen offset:1024 lds
    s_add_u32 s80, s78, 14336
    buffer_load_dwordx4 v252, s[64:67], s80 offen offset:2048 lds
    s_add_u32 s81, s78, 21504
    buffer_load_dwordx4 v252, s[64:67], s81 offen offset:3072 lds
    s_waitcnt vmcnt(25)
    v_mfma_f32_32x32x16_bf16 v[0:15], v[64:67], v[208:211], 0
    v_mfma_f32_32x32x16_bf16 v[16:31], v[64:67], v[212:215], 0
    v_mfma_f32_32x32x16_bf16 v[32:47], v[68:71], v[208:211], 0
    v_mfma_f32_32x32x16_bf16 v[48:63], v[68:71], v[212:215], 0
    v_mfma_f32_32x32x16_bf16 v[0:15], v[72:75], v[216:219], v[0:15]
    v_mfma_f32_32x32x16_bf16 v[16:31], v[72:75], v[220:223], v[16:31]
    v_mfma_f32_32x32x16_bf16 v[32:47], v[76:79], v[216:219], v[32:47]
    v_mfma_f32_32x32x16_bf16 v[48:63], v[76:79], v[220:223], v[48:63]
    v_mov_b32 v249, 3
    ds_write_b32 v248, v249
    ds_read_b64_tr_b16 v[64:65], v246 offset:16384
    ds_read_b64_tr_b16 v[66:67], v246 offset:17408
    ds_read_b64_tr_b16 v[68:69], v247 offset:16384
    ds_read_b64_tr_b16 v[70:71], v247 offset:17408
    ds_read_b64_tr_b16 v[72:73], v246 offset:18432
    ds_read_b64_tr_b16 v[74:75], v246 offset:19456
    ds_read_b64_tr_b16 v[76:77], v247 offset:18432
    ds_read_b64_tr_b16 v[78:79], v247 offset:19456
    s_waitcnt vmcnt(21)
    v_mfma_f32_32x32x16_bf16 v[0:15], v[80:83], v[224:227], v[0:15]
    v_mfma_f32_32x32x16_bf16 v[16:31], v[80:83], v[228:231], v[16:31]
    v_mfma_f32_32x32x16_bf16 v[32:47], v[84:87], v[224:227], v[32:47]
    v_mfma_f32_32x32x16_bf16 v[48:63], v[84:87], v[228:231], v[48:63]
    v_mfma_f32_32x32x16_bf16 v[0:15], v[88:91], v[232:235], v[0:15]
    v_mfma_f32_32x32x16_bf16 v[16:31], v[88:91], v[236:239], v[16:31]
    v_mfma_f32_32x32x16_bf16 v[32:47], v[92:95], v[232:235], v[32:47]
    v_mfma_f32_32x32x16_bf16 v[48:63], v[92:95], v[236:239], v[48:63]
    s_waitcnt vmcnt(12)
    s_mov_b32 s14, 0
    s_nop 9
LA14_P:
    v_cmp_ne_u32 vcc, s3, v250
    s_nop 1
    s_and_b32 vcc_lo, vcc_lo, 0xff
    s_cmp_eq_u32 vcc_lo, 0
    s_nop 0
    s_cbranch_scc1 LA14_G
    s_add_u32 s14, s14, 1
    s_cmp_gt_u32 s14, 0x8000
    s_cbranch_scc1 LA14_G
    s_sleep 8
    buffer_load_dword v250, v253, s[56:59], s86 offen sc1
    s_waitcnt vmcnt(0)
    s_branch LA14_P
LA14_G:
    s_add_u32 s15, s82, 8192
    buffer_load_dwordx4 v[208:211], v254, s[56:59], s15 offen offset:0 sc1
    buffer_load_dwordx4 v[212:215], v254, s[56:59], s15 offen offset:1024 sc1
    buffer_load_dwordx4 v[216:219], v254, s[56:59], s15 offen offset:2048 sc1
    buffer_load_dwordx4 v[220:223], v254, s[56:59], s15 offen offset:3072 sc1
    s_add_u32 s15, s82, 12288
    buffer_load_dwordx4 v[224:227], v254, s[56:59], s15 offen offset:0 sc1
    buffer_load_dwordx4 v[228:231], v254, s[56:59], s15 offen offset:1024 sc1
    buffer_load_dwordx4 v[232:235], v254, s[56:59], s15 offen offset:2048 sc1
    buffer_load_dwordx4 v[236:239], v254, s[56:59], s15 offen offset:3072 sc1
    buffer_load_dword v250, v253, s[56:59], s86 offen sc1
    v_mfma_f32_32x32x16_bf16 v[0:15], v[96:99], v[176:179], v[0:15]
    v_mfma_f32_32x32x16_bf16 v[16:31], v[96:99], v[180:183], v[16:31]
    v_mfma_f32_32x32x16_bf16 v[32:47], v[100:103], v[176:179], v[32:47]
    v_mfma_f32_32x32x16_bf16 v[48:63], v[100:103], v[180:183], v[48:63]
    v_mfma_f32_32x32x16_bf16 v[0:15], v[104:107], v[184:187], v[0:15]
    v_mfma_f32_32x32x16_bf16 v[16:31], v[104:107], v[188:191], v[16:31]
    v_mfma_f32_32x32x16_bf16 v[32:47], v[108:111], v[184:187], v[32:47]
    v_mfma_f32_32x32x16_bf16 v[48:63], v[108:111], v[188:191], v[48:63]
    s_add_u32 s15, s82, 24576
    buffer_load_dwordx4 v[176:179], v254, s[56:59], s15 offen offset:0 sc1
    buffer_load_dwordx4 v[180:183], v254, s[56:59], s15 offen offset:1024 sc1
    buffer_load_dwordx4 v[184:187], v254, s[56:59], s15 offen offset:2048 sc1
    buffer_load_dwordx4 v[188:191], v254, s[56:59], s15 offen offset:3072 sc1
    v_mfma_f32_32x32x16_bf16 v[0:15], v[112:115], v[192:195], v[0:15]
    v_mfma_f32_32x32x16_bf16 v[16:31], v[112:115], v[196:199], v[16:31]
    v_mfma_f32_32x32x16_bf16 v[32:47], v[116:119], v[192:195], v[32:47]
    v_mfma_f32_32x32x16_bf16 v[48:63], v[116:119], v[196:199], v[48:63]
    v_mfma_f32_32x32x16_bf16 v[0:15], v[120:123], v[200:203], v[0:15]
    v_mfma_f32_32x32x16_bf16 v[16:31], v[120:123], v[204:207], v[16:31]
    v_mfma_f32_32x32x16_bf16 v[32:47], v[124:127], v[200:203], v[32:47]
    v_mfma_f32_32x32x16_bf16 v[48:63], v[124:127], v[204:207], v[48:63]
    s_add_u32 s15, s82, 28672
    buffer_load_dwordx4 v[192:195], v254, s[56:59], s15 offen offset:0 sc1
    buffer_load_dwordx4 v[196:199], v254, s[56:59], s15 offen offset:1024 sc1
    buffer_load_dwordx4 v[200:203], v254, s[56:59], s15 offen offset:2048 sc1
    buffer_load_dwordx4 v[204:207], v254, s[56:59], s15 offen offset:3072 sc1
    s_waitcnt vmcnt(17)
    ds_read_b64_tr_b16 v[80:81], v244 offset:0
    ds_read_b64_tr_b16 v[82:83], v244 offset:1024
    ds_read_b64_tr_b16 v[84:85], v245 offset:0
    ds_read_b64_tr_b16 v[86:87], v245 offset:1024
    ds_read_b64_tr_b16 v[88:89], v244 offset:2048
    ds_read_b64_tr_b16 v[90:91], v244 offset:3072
    ds_read_b64_tr_b16 v[92:93], v245 offset:2048
    ds_read_b64_tr_b16 v[94:95], v245 offset:3072
    ds_read_b64_tr_b16 v[96:97], v244 offset:16384
    ds_read_b64_tr_b16 v[98:99], v244 offset:17408
    ds_read_b64_tr_b16 v[100:101], v245 offset:16384
    ds_read_b64_tr_b16 v[102:103], v245 offset:17408
    ds_read_b64_tr_b16 v[104:105], v244 offset:18432
    ds_read_b64_tr_b16 v[106:107], v244 offset:19456
    ds_read_b64_tr_b16 v[108:109], v245 offset:18432
    ds_read_b64_tr_b16 v[110:111], v245 offset:19456
    ds_read_b64_tr_b16 v[112:113], v246 offset:0
    ds_read_b64_tr_b16 v[114:115], v246 offset:1024
    ds_read_b64_tr_b16 v[116:117], v247 offset:0
    ds_read_b64_tr_b16 v[118:119], v247 offset:1024
    ds_read_b64_tr_b16 v[120:121], v246 offset:2048
    ds_read_b64_tr_b16 v[122:123], v246 offset:3072
    ds_read_b64_tr_b16 v[124:125], v247 offset:2048
    ds_read_b64_tr_b16 v[126:127], v247 offset:3072
    s_waitcnt vmcnt(13)
    v_mfma_f32_32x32x16_bf16 v[0:15], v[128:131], v[208:211], v[0:15]
    v_mfma_f32_32x32x16_bf16 v[16:31], v[128:131], v[212:215], v[16:31]
    v_mfma_f32_32x32x16_bf16 v[32:47], v[132:135], v[208:211], v[32:47]
    v_mfma_f32_32x32x16_bf16 v[48:63], v[132:135], v[212:215], v[48:63]
    v_mfma_f32_32x32x16_bf16 v[0:15], v[136:139], v[216:219], v[0:15]
    v_mfma_f32_32x32x16_bf16 v[16:31], v[136:139], v[220:223], v[16:31]
    v_mfma_f32_32x32x16_bf16 v[32:47], v[140:143], v[216:219], v[32:47]
    v_mfma_f32_32x32x16_bf16 v[48:63], v[140:143], v[220:223], v[48:63]
    s_waitcnt vmcnt(8)
    s_mov_b32 s14, 0
    s_nop 9
LA18_P:
    v_cmp_ne_u32 vcc, s3, v250
    s_nop 1
    s_and_b32 vcc_lo, vcc_lo, 0x3f00
    s_cmp_eq_u32 vcc_lo, 0
    s_nop 0
    s_cbranch_scc1 LA18_G
    s_add_u32 s14, s14, 1
    s_cmp_gt_u32 s14, 0x8000
    s_cbranch_scc1 LA18_G
    s_sleep 8
    buffer_load_dword v250, v253, s[56:59], s86 offen sc1
    s_waitcnt vmcnt(0)
    s_branch LA18_P
LA18_G:
    s_add_u32 s15, s83, 131072
    buffer_load_dwordx4 v[208:211], v254, s[56:59], s15 offen offset:0 sc1
    buffer_load_dwordx4 v[212:215], v254, s[56:59], s15 offen offset:1024 sc1
    buffer_load_dwordx4 v[216:219], v254, s[56:59], s15 offen offset:2048 sc1
    buffer_load_dwordx4 v[220:223], v254, s[56:59], s15 offen offset:3072 sc1
    v_mfma_f32_32x32x16_bf16 v[0:15], v[144:147], v[224:227], v[0:15]
    v_mfma_f32_32x32x16_bf16 v[16:31], v[144:147], v[228:231], v[16:31]
    v_mfma_f32_32x32x16_bf16 v[32:47], v[148:151], v[224:227], v[32:47]
    v_mfma_f32_32x32x16_bf16 v[48:63], v[148:151], v[228:231], v[48:63]
    v_mfma_f32_32x32x16_bf16 v[0:15], v[152:155], v[232:235], v[0:15]
    v_mfma_f32_32x32x16_bf16 v[16:31], v[152:155], v[236:239], v[16:31]
    v_mfma_f32_32x32x16_bf16 v[32:47], v[156:159], v[232:235], v[32:47]
    v_mfma_f32_32x32x16_bf16 v[48:63], v[156:159], v[236:239], v[48:63]
    s_add_u32 s15, s83, 135168
    buffer_load_dwordx4 v[224:227], v254, s[56:59], s15 offen offset:0 sc1
    buffer_load_dwordx4 v[228:231], v254, s[56:59], s15 offen offset:1024 sc1
    buffer_load_dwordx4 v[232:235], v254, s[56:59], s15 offen offset:2048 sc1
    buffer_load_dwordx4 v[236:239], v254, s[56:59], s15 offen offset:3072 sc1
    s_waitcnt vmcnt(12)
    v_mfma_f32_32x32x16_bf16 v[0:15], v[160:163], v[176:179], v[0:15]
    v_mfma_f32_32x32x16_bf16 v[16:31], v[160:163], v[180:183], v[16:31]
    v_mfma_f32_32x32x16_bf16 v[32:47], v[164:167], v[176:179], v[32:47]
    v_mfma_f32_32x32x16_bf16 v[48:63], v[164:167], v[180:183], v[48:63]
    v_mfma_f32_32x32x16_bf16 v[0:15], v[168:171], v[184:187], v[0:15]
    v_mfma_f32_32x32x16_bf16 v[16:31], v[168:171], v[188:191], v[16:31]
    v_mfma_f32_32x32x16_bf16 v[32:47], v[172:175], v[184:187], v[32:47]
    v_mfma_f32_32x32x16_bf16 v[48:63], v[172:175], v[188:191], v[48:63]
    s_add_u32 s15, s83, 139264
    buffer_load_dwordx4 v[176:179], v254, s[56:59], s15 offen offset:0 sc1
    buffer_load_dwordx4 v[180:183], v254, s[56:59], s15 offen offset:1024 sc1
    buffer_load_dwordx4 v[184:187], v254, s[56:59], s15 offen offset:2048 sc1
    buffer_load_dwordx4 v[188:191], v254, s[56:59], s15 offen offset:3072 sc1
    v_lshrrev_b32 v240, 3, v255
    v_and_b32 v241, 7, v255
    v_lshlrev_b32 v240, 10, v240
    v_lshl_add_u32 v240, v241, 4, v240
    s_lshl_b32 s6, s12, 3
    s_add_u32 s6, s6, s4
    s_lshl_b32 s6, s6, 13
    s_lshl_b32 s7, s13, 7
    s_add_u32 s6, s6, s7
    buffer_load_dwordx4 v[244:247], v240, s[40:43], s6 offen
    s_waitcnt vmcnt(13)
    s_waitcnt lgkmcnt(14)
    v_mfma_f32_32x32x16_bf16 v[0:15], v[64:67], v[192:195], v[0:15]
    v_mfma_f32_32x32x16_bf16 v[16:31], v[64:67], v[196:199], v[16:31]
    v_mfma_f32_32x32x16_bf16 v[32:47], v[68:71], v[192:195], v[32:47]
    v_mfma_f32_32x32x16_bf16 v[48:63], v[68:71], v[196:199], v[48:63]
    v_mfma_f32_32x32x16_bf16 v[0:15], v[72:75], v[200:203], v[0:15]
    v_mfma_f32_32x32x16_bf16 v[16:31], v[72:75], v[204:207], v[16:31]
    v_mfma_f32_32x32x16_bf16 v[32:47], v[76:79], v[200:203], v[32:47]
    v_mfma_f32_32x32x16_bf16 v[48:63], v[76:79], v[204:207], v[48:63]
    s_waitcnt vmcnt(9)
    v_mfma_f32_32x32x16_bf16 v[0:15], v[80:83], v[208:211], v[0:15]
    v_mfma_f32_32x32x16_bf16 v[16:31], v[80:83], v[212:215], v[16:31]
    v_mfma_f32_32x32x16_bf16 v[32:47], v[84:87], v[208:211], v[32:47]
    v_mfma_f32_32x32x16_bf16 v[48:63], v[84:87], v[212:215], v[48:63]
    v_mfma_f32_32x32x16_bf16 v[0:15], v[88:91], v[216:219], v[0:15]
    v_mfma_f32_32x32x16_bf16 v[16:31], v[88:91], v[220:223], v[16:31]
    v_mfma_f32_32x32x16_bf16 v[32:47], v[92:95], v[216:219], v[32:47]
    v_mfma_f32_32x32x16_bf16 v[48:63], v[92:95], v[220:223], v[48:63]
    s_lshl_b32 s14, s85, 1
    v_and_b32 v64, 31, v255
    v_lshrrev_b32 v65, 5, v255
    v_xor_b32 v65, v65, v255
    v_and_b32 v65, 7, v65
    v_lshlrev_b32 v65, 4, v65
    v_lshl_add_u32 v64, v64, 7, v65
    v_add_u32 v64, s14, v64
    v_xor_b32 v65, 32, v64
    v_xor_b32 v66, 64, v64
    v_xor_b32 v67, 96, v64
    v_xor_b32 v68, 16, v64
    v_add_u32 v68, 65536, v68
    v_xor_b32 v69, 16, v65
    v_add_u32 v69, 65536, v69
    v_xor_b32 v70, 16, v66
    v_add_u32 v70, 65536, v70
    v_xor_b32 v71, 16, v67
    v_add_u32 v71, 65536, v71
    s_waitcnt vmcnt(5)
    s_waitcnt lgkmcnt(8)
    v_mfma_f32_32x32x16_bf16 v[0:15], v[96:99], v[224:227], v[0:15]
    v_mfma_f32_32x32x16_bf16 v[16:31], v[96:99], v[228:231], v[16:31]
    v_mfma_f32_32x32x16_bf16 v[32:47], v[100:103], v[224:227], v[32:47]
    v_mfma_f32_32x32x16_bf16 v[48:63], v[100:103], v[228:231], v[48:63]
    v_mfma_f32_32x32x16_bf16 v[0:15], v[104:107], v[232:235], v[0:15]
    v_mfma_f32_32x32x16_bf16 v[16:31], v[104:107], v[236:239], v[16:31]
    v_mfma_f32_32x32x16_bf16 v[32:47], v[108:111], v[232:235], v[32:47]
    v_mfma_f32_32x32x16_bf16 v[48:63], v[108:111], v[236:239], v[48:63]
    s_waitcnt vmcnt(1)
    s_waitcnt lgkmcnt(0)
    v_mfma_f32_32x32x16_bf16 v[0:15], v[112:115], v[176:179], v[0:15]
    v_mfma_f32_32x32x16_bf16 v[0:15], v[120:123], v[184:187], v[0:15]
    v_mfma_f32_32x32x16_bf16 v[16:31], v[112:115], v[180:183], v[16:31]
    v_mfma_f32_32x32x16_bf16 v[16:31], v[120:123], v[188:191], v[16:31]
    s_nop 9
    ds_write_b128 v64, v[0:3] offset:0
    ds_write_b128 v65, v[4:7] offset:0
    ds_write_b128 v66, v[8:11] offset:0
    ds_write_b128 v67, v[12:15] offset:0
    v_mfma_f32_32x32x16_bf16 v[32:47], v[116:119], v[176:179], v[32:47]
    v_mfma_f32_32x32x16_bf16 v[32:47], v[124:127], v[184:187], v[32:47]
    ds_write_b128 v64, v[16:19] offset:16384
    ds_write_b128 v65, v[20:23] offset:16384
    ds_write_b128 v66, v[24:27] offset:16384
    ds_write_b128 v67, v[28:31] offset:16384
    v_mfma_f32_32x32x16_bf16 v[48:63], v[116:119], v[180:183], v[48:63]
    v_mfma_f32_32x32x16_bf16 v[48:63], v[124:127], v[188:191], v[48:63]
    s_nop 5
    ds_write_b128 v68, v[32:35] offset:0
    ds_write_b128 v69, v[36:39] offset:0
    ds_write_b128 v70, v[40:43] offset:0
    ds_write_b128 v71, v[44:47] offset:0
    s_nop 1
    ds_write_b128 v68, v[48:51] offset:16384
    ds_write_b128 v69, v[52:55] offset:16384
    ds_write_b128 v70, v[56:59] offset:16384
    ds_write_b128 v71, v[60:63] offset:16384
    s_branch F_START
C_START:
    s_and_b32 s86, s84, 1
    s_lshr_b32 s87, s84, 1
    s_lshl_b32 s85, s5, 1
    s_add_u32 s85, s85, s87
    s_mov_b32 s52, 0x3fb8aa3b
    s_mov_b32 s53, 0x3fb8aa3b
    s_mov_b32 s54, 0.5
    s_mov_b32 s55, 1.0
    v_mov_b32 v0, 0x7f000000
    v_cmp_eq_u32 vcc, 0, v255
    s_nop 1
    v_cndmask_b32 v249, v0, 0, vcc
    v_lshrrev_b32 v0, 5, v255
    v_bfe_u32 v1, v255, 2, 2
    v_mul_u32_u24 v0, 8, v0
    v_add_lshl_u32 v244, v0, v1, 7
    v_bfe_u32 v0, v255, 3, 1
    v_xor_b32 v0, s86, v0
    v_lshl_add_u32 v244, v0, 6, v244
    v_bfe_u32 v0, v255, 4, 1
    v_lshl_add_u32 v244, v0, 5, v244
    v_and_b32 v0, 3, v255
    v_lshl_add_u32 v244, v0, 3, v244
    v_add_u32 v244, 65536, v244
    v_lshrrev_b32 v0, 5, v255
    v_and_b32 v1, 31, v255
    v_bfe_u32 v2, v255, 1, 3
    v_xor_b32 v2, v2, v0
    v_lshlrev_b32 v2, 4, v2
    v_lshl_add_u32 v2, v1, 7, v2
    s_lshl_b32 s14, s84, 12
    v_add_u32 v228, s14, v2
    v_xor_b32 v229, 32, v228
    v_xor_b32 v230, 64, v228
    v_xor_b32 v231, 96, v228
    v_xor_b32 v232, 0x1000, v228
    v_xor_b32 v233, 0x1000, v229
    v_xor_b32 v234, 0x1000, v230
    v_xor_b32 v235, 0x1000, v231
    v_lshlrev_b32 v2, 3, v1
    v_lshl_add_u32 v2, v0, 2, v2
    v_add_u32 v245, 131072, v2
    s_lshl_b32 s14, s84, 8
    s_add_u32 s14, s14, 133120
    v_add_u32 v246, s14, v2
    s_lshl_b32 s14, s84, 7
    s_add_u32 s14, s14, 134144
    v_lshl_add_u32 v247, v1, 2, s14
    v_bfe_u32 v2, v255, 2, 2
    v_lshl_add_u32 v2, v0, 2, v2
    v_bfe_u32 v3, v255, 4, 1
    v_bfe_u32 v4, v255, 1, 1
    v_lshl_add_u32 v4, v3, 1, v4
    v_lshlrev_b32 v4, 3, v4
    v_lshl_add_u32 v248, v2, 5, v4
    s_and_b32 s14, s86, s9
    s_lshl_b32 s14, s14, 10
    s_add_u32 s14, s14, 137216
    v_add_u32 v248, s14, v248
    v_and_b32 v2, 1, v255
    v_bfe_u32 v3, v255, 2, 1
    v_xor_b32 v4, v3, v0
    v_lshl_or_b32 v4, v4, 1, v2
    v_bfe_u32 v5, v255, 1, 1
    v_lshl_or_b32 v4, v5, 2, v4
    v_lshlrev_b32 v4, 4, v4
    v_lshl_add_u32 v4, v1, 7, v4
    s_lshl_b32 s15, s86, 16
    s_add_u32 s15, s15, 49152
    s_lshl_b32 s14, s84, 12
    s_add_u32 s14, s14, s15
    v_add_u32 v236, s14, v4
    v_bfe_u32 v4, v255, 4, 1
    v_xor_b32 v4, v4, v3
    v_xor_b32 v2, v2, v0
    v_lshl_or_b32 v4, v2, 1, v4
    v_bfe_u32 v2, v255, 3, 1
    v_xor_b32 v2, s87, v2
    v_lshl_or_b32 v4, v2, 2, v4
    v_lshl_or_b32 v4, v4, 1, v5
    v_lshlrev_b32 v4, 3, v4
    v_bfe_u32 v2, v255, 2, 2
    v_lshl_add_u32 v2, v0, 2, v2
    v_lshl_add_u32 v4, v2, 7, v4
    s_lshl_b32 s14, s87, 13
    s_add_u32 s14, s14, s15
    v_add_u32 v238, s14, v4
    s_lshl_b32 s15, s86, 13
    s_add_u32 s15, s15, 32768
    s_lshl_b32 s14, s84, 11
    s_add_u32 s14, s14, s15
    v_add_u32 v237, s14, v254
    s_mul_i32 s14, s87, 4352
    s_add_u32 s14, s14, s15
    v_add_u32 v2, s14, v254
    s_lshl_b32 s14, s87, 7
    s_add_u32 s14, s14, 134656
    v_lshl_add_u32 v3, v0, 4, s14
    v_cmp_gt_u32 vcc, 16, v1
    s_nop 1
    v_cndmask_b32 v239, v3, v2, vcc
    v_mov_b32 v2, 1024
    v_cndmask_b32 v240, 32, v2, vcc
    v_lshl_add_u32 v2, v0, 4, v1
    s_lshl_b32 s14, s5, 9
    v_lshl_add_u32 v2, v2, 4, s14
    v_mov_b32 v4, 0x7f000000
    v_cndmask_b32 v241, v4, v2, vcc
    s_lshl_b32 s14, s5, 5
    s_add_u32 s14, s14, 8192
    v_lshl_add_u32 v2, v0, 4, s14
    v_cmp_eq_u32 vcc, 16, v1
    s_nop 1
    v_cndmask_b32 v241, v241, v2, vcc
    s_lshl_b32 s14, s10, 1
    v_add_u32 v2, s14, v255
    v_mul_u32_u24 v3, 43, v2
    v_lshrrev_b32 v3, 7, v3
    v_mul_u32_u24 v3, 104, v3
    v_lshl_add_u32 v2, v2, 3, v3
    v_cmp_gt_u32 vcc, 2, v255
    s_nop 1
    v_cndmask_b32 v242, v4, v2, vcc
    v_lshrrev_b32 v2, 2, v1
    v_and_b32 v3, 3, v255
    v_lshlrev_b32 v3, 2, v3
    v_lshl_add_u32 v2, v2, 7, v3
    v_lshl_add_u32 v2, v0, 15, v2
    s_lshr_b32 s14, s2, 3
    s_lshl_b32 s14, s14, 10
    v_bfe_u32 v2, v255, 2, 2
    v_lshl_add_u32 v2, v2, 7, v3
    v_lshrrev_b32 v3, 4, v255
    v_lshl_add_u32 v2, v3, 15, v2
    s_and_b32 s15, s13, 4
    s_lshl_b32 s15, s15, 7
    s_add_u32 s14, s14, s15
    v_add_u32 v250, s14, v2
    s_lshl_b32 s81, s84, 18
    s_mul_i32 s82, s84, 98304
    s_lshl_b32 s83, s84, 17
    s_mul_i32 s80, s86, 768
    s_waitcnt lgkmcnt(0)
    s_mov_b32 s56, s36
    s_mov_b32 s57, s37
    s_mov_b32 s58, 0xe00000
    s_mov_b32 s59, 0x20000
    s_mov_b32 s40, s16
    s_mov_b32 s41, s17
    s_mov_b32 s42, 0x200000
    s_mov_b32 s43, 0x20000
    s_mov_b32 s64, s30
    s_mov_b32 s65, s31
    s_mov_b32 s66, 0x158000
    s_mov_b32 s67, 0x20000
    s_mov_b32 s68, s22
    s_mov_b32 s69, s23
    s_mov_b32 s70, 0x80000
    s_mov_b32 s71, 0x20000
    s_setprio 1
    s_cmp_eq_u32 s9, 1
    s_cbranch_scc1 CX_START
    v_mov_b32 v8, -1
    v_mov_b32 v9, -1
    v_mov_b32 v10, -1
    v_mov_b32 v11, -1
    s_mul_i32 s15, s85, 245760
    s_barrier
    ds_read_b64_tr_b16 v[192:193], v244 offset:0
    ds_read_b64_tr_b16 v[194:195], v244 offset:512
    ds_read_b128 v[0:3], v228 offset:0
    ds_read_b128 v[216:219], v232 offset:0
    ds_read_b64_tr_b16 v[196:197], v244 offset:8192
    ds_read_b64_tr_b16 v[198:199], v244 offset:8704
    ds_read_b64_tr_b16 v[200:201], v244 offset:2048
    ds_read_b64_tr_b16 v[202:203], v244 offset:2560
    ds_read_b128 v[4:7], v229 offset:0
    ds_read_b128 v[220:223], v233 offset:0
    ds_read_b64_tr_b16 v[204:205], v244 offset:10240
    ds_read_b64_tr_b16 v[206:207], v244 offset:10752
    s_waitcnt lgkmcnt(6)
    v_mfma_f32_32x32x16_bf16 v[128:143], v[192:195], v[0:3], 0
    ds_read_b64_tr_b16 v[208:209], v244 offset:4096
    ds_read_b64_tr_b16 v[210:211], v244 offset:4608
    v_mfma_f32_32x32x16_bf16 v[144:159], v[192:195], v[216:219], 0
    ds_read_b128 v[8:11], v230 offset:0
    ds_read_b128 v[224:227], v234 offset:0
    v_mfma_f32_32x32x16_bf16 v[160:175], v[196:199], v[0:3], 0
    ds_read_b64_tr_b16 v[212:213], v244 offset:12288
    ds_read_b64_tr_b16 v[214:215], v244 offset:12800
    v_mfma_f32_32x32x16_bf16 v[176:191], v[196:199], v[216:219], 0
    s_waitcnt lgkmcnt(6)
    v_mfma_f32_32x32x16_bf16 v[128:143], v[200:203], v[4:7], v[128:143]
    ds_read_b64_tr_b16 v[192:193], v244 offset:6144
    ds_read_b64_tr_b16 v[194:195], v244 offset:6656
    v_mfma_f32_32x32x16_bf16 v[144:159], v[200:203], v[220:223], v[144:159]
    ds_read_b128 v[12:15], v231 offset:0
    ds_read_b128 v[216:219], v235 offset:0
    v_mfma_f32_32x32x16_bf16 v[160:175], v[204:207], v[4:7], v[160:175]
    ds_read_b64_tr_b16 v[196:197], v244 offset:14336
    ds_read_b64_tr_b16 v[198:199], v244 offset:14848
    v_mfma_f32_32x32x16_bf16 v[176:191], v[204:207], v[220:223], v[176:191]
    s_waitcnt lgkmcnt(6)
    v_mfma_f32_32x32x16_bf16 v[128:143], v[208:211], v[8:11], v[128:143]
    s_waitcnt lgkmcnt(0)
    s_barrier
    ds_read_b64_tr_b16 v[200:201], v244 offset:16384
    ds_read_b64_tr_b16 v[202:203], v244 offset:16896
    v_mfma_f32_32x32x16_bf16 v[144:159], v[208:211], v[224:227], v[144:159]
    ds_read_b128 v[16:19], v228 offset:16384
    ds_read_b128 v[220:223], v232 offset:16384
    v_mfma_f32_32x32x16_bf16 v[160:175], v[212:215], v[8:11], v[160:175]
    ds_read_b64_tr_b16 v[204:205], v244 offset:24576
    ds_read_b64_tr_b16 v[206:207], v244 offset:25088
    v_mfma_f32_32x32x16_bf16 v[176:191], v[212:215], v[224:227], v[176:191]
    v_mfma_f32_32x32x16_bf16 v[128:143], v[192:195], v[12:15], v[128:143]
    ds_read_b64_tr_b16 v[208:209], v244 offset:18432
    ds_read_b64_tr_b16 v[210:211], v244 offset:18944
    v_mfma_f32_32x32x16_bf16 v[144:159], v[192:195], v[216:219], v[144:159]
    ds_read_b128 v[20:23], v229 offset:16384
    ds_read_b128 v[224:227], v233 offset:16384
    v_mfma_f32_32x32x16_bf16 v[160:175], v[196:199], v[12:15], v[160:175]
    ds_read_b64_tr_b16 v[212:213], v244 offset:26624
    ds_read_b64_tr_b16 v[214:215], v244 offset:27136
    v_mfma_f32_32x32x16_bf16 v[176:191], v[196:199], v[216:219], v[176:191]
    s_waitcnt lgkmcnt(6)
    v_mfma_f32_32x32x16_bf16 v[128:143], v[200:203], v[16:19], v[128:143]
    ds_read_b64_tr_b16 v[192:193], v244 offset:20480
    ds_read_b64_tr_b16 v[194:195], v244 offset:20992
    v_mfma_f32_32x32x16_bf16 v[144:159], v[200:203], v[220:223], v[144:159]
    ds_read_b128 v[24:27], v230 offset:16384
    ds_read_b128 v[216:219], v234 offset:16384
    v_mfma_f32_32x32x16_bf16 v[160:175], v[204:207], v[16:19], v[160:175]
    ds_read_b64_tr_b16 v[196:197], v244 offset:28672
    ds_read_b64_tr_b16 v[198:199], v244 offset:29184
    v_mfma_f32_32x32x16_bf16 v[176:191], v[204:207], v[220:223], v[176:191]
    s_waitcnt lgkmcnt(6)
    v_mfma_f32_32x32x16_bf16 v[128:143], v[208:211], v[20:23], v[128:143]
    ds_read_b64_tr_b16 v[200:201], v244 offset:22528
    ds_read_b64_tr_b16 v[202:203], v244 offset:23040
    v_mfma_f32_32x32x16_bf16 v[144:159], v[208:211], v[224:227], v[144:159]
    ds_read_b128 v[28:31], v231 offset:16384
    ds_read_b128 v[220:223], v235 offset:16384
    v_mfma_f32_32x32x16_bf16 v[160:175], v[212:215], v[20:23], v[160:175]
    ds_read_b64_tr_b16 v[204:205], v244 offset:30720
    ds_read_b64_tr_b16 v[206:207], v244 offset:31232
    v_mfma_f32_32x32x16_bf16 v[176:191], v[212:215], v[224:227], v[176:191]
    s_waitcnt lgkmcnt(6)
    v_mfma_f32_32x32x16_bf16 v[128:143], v[192:195], v[24:27], v[128:143]
    s_waitcnt lgkmcnt(0)
    s_barrier
    ds_read_b64_tr_b16 v[208:209], v244 offset:32768
    ds_read_b64_tr_b16 v[210:211], v244 offset:33280
    v_mfma_f32_32x32x16_bf16 v[144:159], v[192:195], v[216:219], v[144:159]
    ds_read_b128 v[32:35], v228 offset:32768
    ds_read_b128 v[224:227], v232 offset:32768
    v_mfma_f32_32x32x16_bf16 v[160:175], v[196:199], v[24:27], v[160:175]
    ds_read_b64_tr_b16 v[212:213], v244 offset:40960
    ds_read_b64_tr_b16 v[214:215], v244 offset:41472
    v_mfma_f32_32x32x16_bf16 v[176:191], v[196:199], v[216:219], v[176:191]
    v_mfma_f32_32x32x16_bf16 v[128:143], v[200:203], v[28:31], v[128:143]
    ds_read_b64_tr_b16 v[192:193], v244 offset:34816
    ds_read_b64_tr_b16 v[194:195], v244 offset:35328
    v_mfma_f32_32x32x16_bf16 v[144:159], v[200:203], v[220:223], v[144:159]
    ds_read_b128 v[36:39], v229 offset:32768
    ds_read_b128 v[216:219], v233 offset:32768
    v_mfma_f32_32x32x16_bf16 v[160:175], v[204:207], v[28:31], v[160:175]
    ds_read_b64_tr_b16 v[196:197], v244 offset:43008
    ds_read_b64_tr_b16 v[198:199], v244 offset:43520
    v_mfma_f32_32x32x16_bf16 v[176:191], v[204:207], v[220:223], v[176:191]
    s_waitcnt lgkmcnt(6)
    v_mfma_f32_32x32x16_bf16 v[128:143], v[208:211], v[32:35], v[128:143]
    ds_read_b64_tr_b16 v[200:201], v244 offset:36864
    ds_read_b64_tr_b16 v[202:203], v244 offset:37376
    v_mfma_f32_32x32x16_bf16 v[144:159], v[208:211], v[224:227], v[144:159]
    ds_read_b128 v[40:43], v230 offset:32768
    ds_read_b128 v[220:223], v234 offset:32768
    v_mfma_f32_32x32x16_bf16 v[160:175], v[212:215], v[32:35], v[160:175]
    ds_read_b64_tr_b16 v[204:205], v244 offset:45056
    ds_read_b64_tr_b16 v[206:207], v244 offset:45568
    v_mfma_f32_32x32x16_bf16 v[176:191], v[212:215], v[224:227], v[176:191]
    s_waitcnt lgkmcnt(6)
    v_mfma_f32_32x32x16_bf16 v[128:143], v[192:195], v[36:39], v[128:143]
    ds_read_b64_tr_b16 v[208:209], v244 offset:38912
    ds_read_b64_tr_b16 v[210:211], v244 offset:39424
    v_mfma_f32_32x32x16_bf16 v[144:159], v[192:195], v[216:219], v[144:159]
    ds_read_b128 v[44:47], v231 offset:32768
    ds_read_b128 v[224:227], v235 offset:32768
    v_mfma_f32_32x32x16_bf16 v[160:175], v[196:199], v[36:39], v[160:175]
    ds_read_b64_tr_b16 v[212:213], v244 offset:47104
    ds_read_b64_tr_b16 v[214:215], v244 offset:47616
    v_mfma_f32_32x32x16_bf16 v[176:191], v[196:199], v[216:219], v[176:191]
    s_waitcnt lgkmcnt(6)
    v_mfma_f32_32x32x16_bf16 v[128:143], v[200:203], v[40:43], v[128:143]
    s_waitcnt lgkmcnt(0)
    s_barrier
    ds_read_b64_tr_b16 v[192:193], v244 offset:49152
    ds_read_b64_tr_b16 v[194:195], v244 offset:49664
    v_mfma_f32_32x32x16_bf16 v[144:159], v[200:203], v[220:223], v[144:159]
    ds_read_b128 v[48:51], v228 offset:49152
    ds_read_b128 v[216:219], v232 offset:49152
    v_mfma_f32_32x32x16_bf16 v[160:175], v[204:207], v[40:43], v[160:175]
    ds_read_b64_tr_b16 v[196:197], v244 offset:57344
    ds_read_b64_tr_b16 v[198:199], v244 offset:57856
    v_mfma_f32_32x32x16_bf16 v[176:191], v[204:207], v[220:223], v[176:191]
    v_mfma_f32_32x32x16_bf16 v[128:143], v[208:211], v[44:47], v[128:143]
    ds_read_b64_tr_b16 v[200:201], v244 offset:51200
    ds_read_b64_tr_b16 v[202:203], v244 offset:51712
    v_mfma_f32_32x32x16_bf16 v[144:159], v[208:211], v[224:227], v[144:159]
    ds_read_b128 v[52:55], v229 offset:49152
    ds_read_b128 v[220:223], v233 offset:49152
    v_mfma_f32_32x32x16_bf16 v[160:175], v[212:215], v[44:47], v[160:175]
    ds_read_b64_tr_b16 v[204:205], v244 offset:59392
    ds_read_b64_tr_b16 v[206:207], v244 offset:59904
    v_mfma_f32_32x32x16_bf16 v[176:191], v[212:215], v[224:227], v[176:191]
    s_waitcnt lgkmcnt(6)
    v_mfma_f32_32x32x16_bf16 v[128:143], v[192:195], v[48:51], v[128:143]
    ds_read_b64_tr_b16 v[208:209], v244 offset:53248
    ds_read_b64_tr_b16 v[210:211], v244 offset:53760
    v_mfma_f32_32x32x16_bf16 v[144:159], v[192:195], v[216:219], v[144:159]
    ds_read_b128 v[56:59], v230 offset:49152
    ds_read_b128 v[224:227], v234 offset:49152
    v_mfma_f32_32x32x16_bf16 v[160:175], v[196:199], v[48:51], v[160:175]
    ds_read_b64_tr_b16 v[212:213], v244 offset:61440
    ds_read_b64_tr_b16 v[214:215], v244 offset:61952
    v_mfma_f32_32x32x16_bf16 v[176:191], v[196:199], v[216:219], v[176:191]
    s_waitcnt lgkmcnt(6)
    v_mfma_f32_32x32x16_bf16 v[128:143], v[200:203], v[52:55], v[128:143]
    ds_read_b64_tr_b16 v[192:193], v244 offset:55296
    ds_read_b64_tr_b16 v[194:195], v244 offset:55808
    v_mfma_f32_32x32x16_bf16 v[144:159], v[200:203], v[220:223], v[144:159]
    ds_read_b128 v[60:63], v231 offset:49152
    ds_read_b128 v[216:219], v235 offset:49152
    v_mfma_f32_32x32x16_bf16 v[160:175], v[204:207], v[52:55], v[160:175]
    ds_read_b64_tr_b16 v[196:197], v244 offset:63488
    ds_read_b64_tr_b16 v[198:199], v244 offset:64000
    v_mfma_f32_32x32x16_bf16 v[176:191], v[204:207], v[220:223], v[176:191]
    s_waitcnt lgkmcnt(6)
    v_mfma_f32_32x32x16_bf16 v[128:143], v[208:211], v[56:59], v[128:143]
    s_waitcnt lgkmcnt(0)
    s_barrier
    ds_read_b64_tr_b16 v[200:201], v244 offset:0
    ds_read_b64_tr_b16 v[202:203], v244 offset:512
    v_mfma_f32_32x32x16_bf16 v[144:159], v[208:211], v[224:227], v[144:159]
    ds_read_b128 v[64:67], v228 offset:0
    ds_read_b128 v[220:223], v232 offset:0
    v_mfma_f32_32x32x16_bf16 v[160:175], v[212:215], v[56:59], v[160:175]
    ds_read_b64_tr_b16 v[204:205], v244 offset:8192
    ds_read_b64_tr_b16 v[206:207], v244 offset:8704
    v_mfma_f32_32x32x16_bf16 v[176:191], v[212:215], v[224:227], v[176:191]
    v_mfma_f32_32x32x16_bf16 v[128:143], v[192:195], v[60:63], v[128:143]
    ds_read_b64_tr_b16 v[208:209], v244 offset:2048
    ds_read_b64_tr_b16 v[210:211], v244 offset:2560
    v_mfma_f32_32x32x16_bf16 v[144:159], v[192:195], v[216:219], v[144:159]
    ds_read_b128 v[68:71], v229 offset:0
    ds_read_b128 v[224:227], v233 offset:0
    v_mfma_f32_32x32x16_bf16 v[160:175], v[196:199], v[60:63], v[160:175]
    ds_read_b64_tr_b16 v[212:213], v244 offset:10240
    ds_read_b64_tr_b16 v[214:215], v244 offset:10752
    v_mfma_f32_32x32x16_bf16 v[176:191], v[196:199], v[216:219], v[176:191]
    s_waitcnt lgkmcnt(6)
    v_mfma_f32_32x32x16_bf16 v[128:143], v[200:203], v[64:67], v[128:143]
    ds_read_b64_tr_b16 v[192:193], v244 offset:4096
    ds_read_b64_tr_b16 v[194:195], v244 offset:4608
    v_mfma_f32_32x32x16_bf16 v[144:159], v[200:203], v[220:223], v[144:159]
    ds_read_b128 v[72:75], v230 offset:0
    ds_read_b128 v[216:219], v234 offset:0
    v_mfma_f32_32x32x16_bf16 v[160:175], v[204:207], v[64:67], v[160:175]
    ds_read_b64_tr_b16 v[196:197], v244 offset:12288
    ds_read_b64_tr_b16 v[198:199], v244 offset:12800
    v_mfma_f32_32x32x16_bf16 v[176:191], v[204:207], v[220:223], v[176:191]
    s_waitcnt lgkmcnt(6)
    v_mfma_f32_32x32x16_bf16 v[128:143], v[208:211], v[68:71], v[128:143]
    ds_read_b64_tr_b16 v[200:201], v244 offset:6144
    ds_read_b64_tr_b16 v[202:203], v244 offset:6656
    v_mfma_f32_32x32x16_bf16 v[144:159], v[208:211], v[224:227], v[144:159]
    ds_read_b128 v[76:79], v231 offset:0
    ds_read_b128 v[220:223], v235 offset:0
    v_mfma_f32_32x32x16_bf16 v[160:175], v[212:215], v[68:71], v[160:175]
    ds_read_b64_tr_b16 v[204:205], v244 offset:14336
    ds_read_b64_tr_b16 v[206:207], v244 offset:14848
    v_mfma_f32_32x32x16_bf16 v[176:191], v[212:215], v[224:227], v[176:191]
    s_waitcnt lgkmcnt(6)
    v_mfma_f32_32x32x16_bf16 v[128:143], v[192:195], v[72:75], v[128:143]
    s_waitcnt lgkmcnt(0)
    s_barrier
    ds_read_b64_tr_b16 v[208:209], v244 offset:16384
    ds_read_b64_tr_b16 v[210:211], v244 offset:16896
    v_mfma_f32_32x32x16_bf16 v[144:159], v[192:195], v[216:219], v[144:159]
    ds_read_b128 v[80:83], v228 offset:16384
    ds_read_b128 v[224:227], v232 offset:16384
    v_mfma_f32_32x32x16_bf16 v[160:175], v[196:199], v[72:75], v[160:175]
    ds_read_b64_tr_b16 v[212:213], v244 offset:24576
    ds_read_b64_tr_b16 v[214:215], v244 offset:25088
    v_mfma_f32_32x32x16_bf16 v[176:191], v[196:199], v[216:219], v[176:191]
    s_add_u32 s14, s81, 0
    buffer_load_dword v251, v250, s[64:67], s14 offen
    v_mfma_f32_32x32x16_bf16 v[128:143], v[200:203], v[76:79], v[128:143]
    ds_read_b64_tr_b16 v[192:193], v244 offset:18432
    ds_read_b64_tr_b16 v[194:195], v244 offset:18944
    v_mfma_f32_32x32x16_bf16 v[144:159], v[200:203], v[220:223], v[144:159]
    ds_read_b128 v[84:87], v229 offset:16384
    ds_read_b128 v[216:219], v233 offset:16384
    v_mfma_f32_32x32x16_bf16 v[160:175], v[204:207], v[76:79], v[160:175]
    ds_read_b64_tr_b16 v[196:197], v244 offset:26624
    ds_read_b64_tr_b16 v[198:199], v244 offset:27136
    v_mfma_f32_32x32x16_bf16 v[176:191], v[204:207], v[220:223], v[176:191]
    s_waitcnt lgkmcnt(6)
    v_mfma_f32_32x32x16_bf16 v[128:143], v[208:211], v[80:83], v[128:143]
    ds_read_b64_tr_b16 v[200:201], v244 offset:20480
    ds_read_b64_tr_b16 v[202:203], v244 offset:20992
    v_mfma_f32_32x32x16_bf16 v[144:159], v[208:211], v[224:227], v[144:159]
    ds_read_b128 v[88:91], v230 offset:16384
    ds_read_b128 v[220:223], v234 offset:16384
    v_mfma_f32_32x32x16_bf16 v[160:175], v[212:215], v[80:83], v[160:175]
    ds_read_b64_tr_b16 v[204:205], v244 offset:28672
    ds_read_b64_tr_b16 v[206:207], v244 offset:29184
    v_mfma_f32_32x32x16_bf16 v[176:191], v[212:215], v[224:227], v[176:191]
    s_add_u32 s14, s81, 131072
    buffer_load_dword v251, v250, s[64:67], s14 offen
    s_waitcnt lgkmcnt(6)
    v_mfma_f32_32x32x16_bf16 v[128:143], v[192:195], v[84:87], v[128:143]
    ds_read_b64_tr_b16 v[208:209], v244 offset:22528
    ds_read_b64_tr_b16 v[210:211], v244 offset:23040
    v_mfma_f32_32x32x16_bf16 v[144:159], v[192:195], v[216:219], v[144:159]
    ds_read_b128 v[92:95], v231 offset:16384
    ds_read_b128 v[224:227], v235 offset:16384
    v_mfma_f32_32x32x16_bf16 v[160:175], v[196:199], v[84:87], v[160:175]
    ds_read_b64_tr_b16 v[212:213], v244 offset:30720
    ds_read_b64_tr_b16 v[214:215], v244 offset:31232
    v_mfma_f32_32x32x16_bf16 v[176:191], v[196:199], v[216:219], v[176:191]
    s_waitcnt lgkmcnt(6)
    v_mfma_f32_32x32x16_bf16 v[128:143], v[200:203], v[88:91], v[128:143]
    s_waitcnt lgkmcnt(0)
    s_barrier
    ds_read_b64_tr_b16 v[192:193], v244 offset:32768
    ds_read_b64_tr_b16 v[194:195], v244 offset:33280
    v_mfma_f32_32x32x16_bf16 v[144:159], v[200:203], v[220:223], v[144:159]
    ds_read_b128 v[96:99], v228 offset:32768
    ds_read_b128 v[216:219], v232 offset:32768
    v_mfma_f32_32x32x16_bf16 v[160:175], v[204:207], v[88:91], v[160:175]
    ds_read_b64_tr_b16 v[196:197], v244 offset:40960
    ds_read_b64_tr_b16 v[198:199], v244 offset:41472
    v_mfma_f32_32x32x16_bf16 v[176:191], v[204:207], v[220:223], v[176:191]
    s_add_u32 s14, s83, 0
    buffer_load_dword v251, v250, s[68:71], s14 offen
    v_mfma_f32_32x32x16_bf16 v[128:143], v[208:211], v[92:95], v[128:143]
    ds_read_b64_tr_b16 v[200:201], v244 offset:34816
    ds_read_b64_tr_b16 v[202:203], v244 offset:35328
    v_mfma_f32_32x32x16_bf16 v[144:159], v[208:211], v[224:227], v[144:159]
    ds_read_b128 v[100:103], v229 offset:32768
    ds_read_b128 v[220:223], v233 offset:32768
    v_mfma_f32_32x32x16_bf16 v[160:175], v[212:215], v[92:95], v[160:175]
    ds_read_b64_tr_b16 v[204:205], v244 offset:43008
    ds_read_b64_tr_b16 v[206:207], v244 offset:43520
    v_mfma_f32_32x32x16_bf16 v[176:191], v[212:215], v[224:227], v[176:191]
    s_waitcnt lgkmcnt(6)
    v_mfma_f32_32x32x16_bf16 v[128:143], v[192:195], v[96:99], v[128:143]
    ds_read_b64_tr_b16 v[208:209], v244 offset:36864
    ds_read_b64_tr_b16 v[210:211], v244 offset:37376
    v_mfma_f32_32x32x16_bf16 v[144:159], v[192:195], v[216:219], v[144:159]
    ds_read_b128 v[104:107], v230 offset:32768
    ds_read_b128 v[224:227], v234 offset:32768
    v_mfma_f32_32x32x16_bf16 v[160:175], v[196:199], v[96:99], v[160:175]
    ds_read_b64_tr_b16 v[212:213], v244 offset:45056
    ds_read_b64_tr_b16 v[214:215], v244 offset:45568
    v_mfma_f32_32x32x16_bf16 v[176:191], v[196:199], v[216:219], v[176:191]
    s_add_u32 s14, s82, 1048576
    buffer_load_dword v251, v250, s[64:67], s14 offen
    s_waitcnt lgkmcnt(6)
    v_mfma_f32_32x32x16_bf16 v[128:143], v[200:203], v[100:103], v[128:143]
    ds_read_b64_tr_b16 v[192:193], v244 offset:38912
    ds_read_b64_tr_b16 v[194:195], v244 offset:39424
    v_mfma_f32_32x32x16_bf16 v[144:159], v[200:203], v[220:223], v[144:159]
    ds_read_b128 v[108:111], v231 offset:32768
    ds_read_b128 v[216:219], v235 offset:32768
    v_mfma_f32_32x32x16_bf16 v[160:175], v[204:207], v[100:103], v[160:175]
    ds_read_b64_tr_b16 v[196:197], v244 offset:47104
    ds_read_b64_tr_b16 v[198:199], v244 offset:47616
    v_mfma_f32_32x32x16_bf16 v[176:191], v[204:207], v[220:223], v[176:191]
    s_waitcnt lgkmcnt(6)
    v_mfma_f32_32x32x16_bf16 v[128:143], v[208:211], v[104:107], v[128:143]
    s_waitcnt lgkmcnt(0)
    s_barrier
    ds_read_b64_tr_b16 v[200:201], v244 offset:49152
    ds_read_b64_tr_b16 v[202:203], v244 offset:49664
    v_mfma_f32_32x32x16_bf16 v[144:159], v[208:211], v[224:227], v[144:159]
    ds_read_b128 v[112:115], v228 offset:49152
    ds_read_b128 v[220:223], v232 offset:49152
    v_mfma_f32_32x32x16_bf16 v[160:175], v[212:215], v[104:107], v[160:175]
    ds_read_b64_tr_b16 v[204:205], v244 offset:57344
    ds_read_b64_tr_b16 v[206:207], v244 offset:57856
    v_mfma_f32_32x32x16_bf16 v[176:191], v[212:215], v[224:227], v[176:191]
    v_mfma_f32_32x32x16_bf16 v[128:143], v[192:195], v[108:111], v[128:143]
    ds_read_b64_tr_b16 v[208:209], v244 offset:51200
    ds_read_b64_tr_b16 v[210:211], v244 offset:51712
    v_mfma_f32_32x32x16_bf16 v[144:159], v[192:195], v[216:219], v[144:159]
    ds_read_b128 v[116:119], v229 offset:49152
    ds_read_b128 v[224:227], v233 offset:49152
    v_mfma_f32_32x32x16_bf16 v[160:175], v[196:199], v[108:111], v[160:175]
    ds_read_b64_tr_b16 v[212:213], v244 offset:59392
    ds_read_b64_tr_b16 v[214:215], v244 offset:59904
    v_mfma_f32_32x32x16_bf16 v[176:191], v[196:199], v[216:219], v[176:191]
    s_waitcnt lgkmcnt(6)
    v_mfma_f32_32x32x16_bf16 v[128:143], v[200:203], v[112:115], v[128:143]
    ds_read_b64_tr_b16 v[192:193], v244 offset:53248
    ds_read_b64_tr_b16 v[194:195], v244 offset:53760
    v_mfma_f32_32x32x16_bf16 v[144:159], v[200:203], v[220:223], v[144:159]
    ds_read_b128 v[120:123], v230 offset:49152
    ds_read_b128 v[216:219], v234 offset:49152
    v_mfma_f32_32x32x16_bf16 v[160:175], v[204:207], v[112:115], v[160:175]
    ds_read_b64_tr_b16 v[196:197], v244 offset:61440
    ds_read_b64_tr_b16 v[198:199], v244 offset:61952
    v_mfma_f32_32x32x16_bf16 v[176:191], v[204:207], v[220:223], v[176:191]
    s_waitcnt lgkmcnt(6)
    v_mfma_f32_32x32x16_bf16 v[128:143], v[208:211], v[116:119], v[128:143]
    ds_read_b64_tr_b16 v[200:201], v244 offset:55296
    ds_read_b64_tr_b16 v[202:203], v244 offset:55808
    v_mfma_f32_32x32x16_bf16 v[144:159], v[208:211], v[224:227], v[144:159]
    ds_read_b128 v[124:127], v231 offset:49152
    ds_read_b128 v[220:223], v235 offset:49152
    v_mfma_f32_32x32x16_bf16 v[160:175], v[212:215], v[116:119], v[160:175]
    ds_read_b64_tr_b16 v[204:205], v244 offset:63488
    ds_read_b64_tr_b16 v[206:207], v244 offset:64000
    v_mfma_f32_32x32x16_bf16 v[176:191], v[212:215], v[224:227], v[176:191]
    v_add_u32 v208, s80, v245
    v_xor_b32 v228, 256, v246
    v_xor_b32 v234, 128, v247
    v_mov_b32 v252, 134912
    s_waitcnt lgkmcnt(6)
    v_mfma_f32_32x32x16_bf16 v[128:143], v[192:195], v[120:123], v[128:143]
    s_waitcnt lgkmcnt(0)
    s_barrier
    ds_read_b32 v212, v208 offset:256
    ds_read_b32 v208, v208
    ds_read_b32 v224, v246
    v_mfma_f32_32x32x16_bf16 v[144:159], v[192:195], v[216:219], v[144:159]
    ds_read_b32 v228, v228
    ds_read_b32 v232, v247
    ds_read_b32 v234, v234
    v_mfma_f32_32x32x16_bf16 v[160:175], v[196:199], v[120:123], v[160:175]
    ds_read_b32 v252, v252
    v_mfma_f32_32x32x16_bf16 v[176:191], v[196:199], v[216:219], v[176:191]
    v_mfma_f32_32x32x16_bf16 v[128:143], v[200:203], v[124:127], v[128:143]
    v_mov_b32 v209, 0
    v_mov_b32 v210, 0
    v_mov_b32 v211, 0
    v_mov_b32 v213, 0
    v_mfma_f32_32x32x16_bf16 v[144:159], v[200:203], v[220:223], v[144:159]
    v_mov_b32 v214, 0
    v_mov_b32 v215, 0
    v_mov_b32 v225, 0
    v_mov_b32 v226, 0
    v_mfma_f32_32x32x16_bf16 v[160:175], v[204:207], v[124:127], v[160:175]
    v_mov_b32 v227, 0
    v_mov_b32 v229, 0
    v_mov_b32 v230, 0
    v_mov_b32 v231, 0
    v_mfma_f32_32x32x16_bf16 v[176:191], v[204:207], v[220:223], v[176:191]
    s_setprio 1
    s_waitcnt lgkmcnt(0)
    v_mfma_f32_32x32x16_bf16 v[128:143], v[208:211], v[224:227], v[128:143]
    v_mfma_f32_32x32x16_bf16 v[144:159], v[208:211], v[228:231], v[144:159]
    v_mfma_f32_32x32x16_bf16 v[160:175], v[212:215], v[224:227], v[160:175]
    v_mfma_f32_32x32x16_bf16 v[176:191], v[212:215], v[228:231], v[176:191]
    v_mov_b32 v236, v232
    v_mul_f32 v232, 0x3fb8aa3b, v232
    v_mul_f32 v234, 0x3fb8aa3b, v234
    v_readfirstlane_b32 s3, v252
    s_lshl_b32 s83, s85, 10
    s_add_u32 s83, s83, 0xc90000
    s_mul_i32 s82, s85, 245760
    s_lshl_b32 s14, s86, 10
    s_add_u32 s82, s82, s14
    s_lshl_b32 s14, s10, 2
    s_add_u32 s14, s14, s86
    s_lshl_b32 s14, s14, 12
    s_add_u32 s78, s82, s14
    s_xor_b32 s79, s78, 1024
    s_add_u32 s48, s78, 8192
    s_add_u32 s49, s79, 8192
    s_lshr_b32 s14, s10, 1
    s_lshl_b32 s14, s14, 5
    s_and_b32 s15, s10, 1
    s_lshl_b32 s15, s15, 1
    s_add_u32 s14, s14, s15
    s_add_u32 s14, s14, s86
    s_lshl_b32 s14, s14, 2
    s_add_u32 s77, s83, s14
    s_lshr_b32 s14, s39, 2
    s_lshl_b32 s14, s14, 1
    s_add_u32 s14, s14, s86
    s_lshl_b32 s14, s14, 5
    s_and_b32 s15, s39, 3
    s_add_u32 s14, s14, s15
    s_lshl_b32 s14, s14, 2
    s_add_u32 s83, s83, s14
    s_lshl_b32 s14, s39, 13
    s_add_u32 s82, s82, s14
    s_add_u32 s82, s82, 180224
    v_pk_mul_f32 v[128:129], v[128:129], v[232:233] op_sel_hi:[1,0]
    v_pk_mul_f32 v[130:131], v[130:131], v[232:233] op_sel_hi:[1,0]
    v_pk_mul_f32 v[132:133], v[132:133], v[232:233] op_sel_hi:[1,0]
    v_pk_mul_f32 v[134:135], v[134:135], v[232:233] op_sel_hi:[1,0]
    v_pk_mul_f32 v[136:137], v[136:137], v[232:233] op_sel_hi:[1,0]
    v_pk_mul_f32 v[138:139], v[138:139], v[232:233] op_sel_hi:[1,0]
    v_pk_mul_f32 v[140:141], v[140:141], v[232:233] op_sel_hi:[1,0]
    v_pk_mul_f32 v[142:143], v[142:143], v[232:233] op_sel_hi:[1,0]
    v_exp_f32 v192, v128
    v_exp_f32 v193, v129
    v_exp_f32 v194, v130
    v_exp_f32 v195, v131
    v_exp_f32 v196, v132
    v_exp_f32 v197, v133
    v_exp_f32 v198, v134
    v_exp_f32 v199, v135
    v_exp_f32 v200, v136
    v_exp_f32 v201, v137
    v_exp_f32 v202, v138
    v_exp_f32 v203, v139
    v_exp_f32 v204, v140
    v_exp_f32 v205, v141
    v_exp_f32 v206, v142
    v_exp_f32 v207, v143
    v_pk_fma_f32 v[208:209], v[192:193], s[54:55], s[54:55] op_sel:[0,0,1] op_sel_hi:[1,0,1]
    v_pk_fma_f32 v[210:211], v[194:195], s[54:55], s[54:55] op_sel:[0,0,1] op_sel_hi:[1,0,1]
    v_pk_fma_f32 v[212:213], v[196:197], s[54:55], s[54:55] op_sel:[0,0,1] op_sel_hi:[1,0,1]
    v_pk_fma_f32 v[214:215], v[198:199], s[54:55], s[54:55] op_sel:[0,0,1] op_sel_hi:[1,0,1]
    v_pk_fma_f32 v[216:217], v[200:201], s[54:55], s[54:55] op_sel:[0,0,1] op_sel_hi:[1,0,1]
    v_pk_fma_f32 v[218:219], v[202:203], s[54:55], s[54:55] op_sel:[0,0,1] op_sel_hi:[1,0,1]
    v_pk_fma_f32 v[220:221], v[204:205], s[54:55], s[54:55] op_sel:[0,0,1] op_sel_hi:[1,0,1]
    v_pk_fma_f32 v[222:223], v[206:207], s[54:55], s[54:55] op_sel:[0,0,1] op_sel_hi:[1,0,1]
    v_pk_fma_f32 v[208:209], v[192:193], v[208:209], s[54:55] op_sel:[0,0,1] op_sel_hi:[1,1,1]
    v_pk_fma_f32 v[210:211], v[194:195], v[210:211], s[54:55] op_sel:[0,0,1] op_sel_hi:[1,1,1]
    v_pk_fma_f32 v[212:213], v[196:197], v[212:213], s[54:55] op_sel:[0,0,1] op_sel_hi:[1,1,1]
    v_pk_fma_f32 v[214:215], v[198:199], v[214:215], s[54:55] op_sel:[0,0,1] op_sel_hi:[1,1,1]
    v_pk_fma_f32 v[216:217], v[200:201], v[216:217], s[54:55] op_sel:[0,0,1] op_sel_hi:[1,1,1]
    v_pk_fma_f32 v[218:219], v[202:203], v[218:219], s[54:55] op_sel:[0,0,1] op_sel_hi:[1,1,1]
    v_pk_fma_f32 v[220:221], v[204:205], v[220:221], s[54:55] op_sel:[0,0,1] op_sel_hi:[1,1,1]
    v_pk_fma_f32 v[222:223], v[206:207], v[222:223], s[54:55] op_sel:[0,0,1] op_sel_hi:[1,1,1]
    v_rcp_f32 v208, v208
    v_rcp_f32 v209, v209
    v_rcp_f32 v210, v210
    v_rcp_f32 v211, v211
    v_rcp_f32 v212, v212
    v_rcp_f32 v213, v213
    v_rcp_f32 v214, v214
    v_rcp_f32 v215, v215
    v_rcp_f32 v216, v216
    v_rcp_f32 v217, v217
    v_rcp_f32 v218, v218
    v_rcp_f32 v219, v219
    v_rcp_f32 v220, v220
    v_rcp_f32 v221, v221
    v_rcp_f32 v222, v222
    v_rcp_f32 v223, v223
    v_pk_fma_f32 v[128:129], v[128:129], v[208:209], v[128:129] neg_lo:[1,0,0] neg_hi:[1,0,0]
    v_pk_fma_f32 v[130:131], v[130:131], v[210:211], v[130:131] neg_lo:[1,0,0] neg_hi:[1,0,0]
    v_pk_fma_f32 v[132:133], v[132:133], v[212:213], v[132:133] neg_lo:[1,0,0] neg_hi:[1,0,0]
    v_pk_fma_f32 v[134:135], v[134:135], v[214:215], v[134:135] neg_lo:[1,0,0] neg_hi:[1,0,0]
    v_pk_fma_f32 v[136:137], v[136:137], v[216:217], v[136:137] neg_lo:[1,0,0] neg_hi:[1,0,0]
    v_pk_fma_f32 v[138:139], v[138:139], v[218:219], v[138:139] neg_lo:[1,0,0] neg_hi:[1,0,0]
    v_pk_fma_f32 v[140:141], v[140:141], v[220:221], v[140:141] neg_lo:[1,0,0] neg_hi:[1,0,0]
    v_pk_fma_f32 v[142:143], v[142:143], v[222:223], v[142:143] neg_lo:[1,0,0] neg_hi:[1,0,0]
    v_cvt_pk_bf16_f32 v128, v128, v129
    v_cvt_pk_bf16_f32 v129, v130, v131
    v_cvt_pk_bf16_f32 v130, v132, v133
    v_cvt_pk_bf16_f32 v131, v134, v135
    v_cvt_pk_bf16_f32 v132, v136, v137
    v_cvt_pk_bf16_f32 v133, v138, v139
    v_cvt_pk_bf16_f32 v134, v140, v141
    v_cvt_pk_bf16_f32 v135, v142, v143
    buffer_store_dwordx4 v[128:131], v254, s[56:59], s78 offen sc1
    buffer_store_dwordx4 v[132:135], v254, s[56:59], s78 offen offset:2048 sc1
    v_pk_mul_f32 v[144:145], v[144:145], v[234:235] op_sel_hi:[1,0]
    v_pk_mul_f32 v[146:147], v[146:147], v[234:235] op_sel_hi:[1,0]
    v_pk_mul_f32 v[148:149], v[148:149], v[234:235] op_sel_hi:[1,0]
    v_pk_mul_f32 v[150:151], v[150:151], v[234:235] op_sel_hi:[1,0]
    v_pk_mul_f32 v[152:153], v[152:153], v[234:235] op_sel_hi:[1,0]
    v_pk_mul_f32 v[154:155], v[154:155], v[234:235] op_sel_hi:[1,0]
    v_pk_mul_f32 v[156:157], v[156:157], v[234:235] op_sel_hi:[1,0]
    v_pk_mul_f32 v[158:159], v[158:159], v[234:235] op_sel_hi:[1,0]
    v_exp_f32 v192, v144
    v_exp_f32 v193, v145
    v_exp_f32 v194, v146
    v_exp_f32 v195, v147
    v_exp_f32 v196, v148
    v_exp_f32 v197, v149
    v_exp_f32 v198, v150
    v_exp_f32 v199, v151
    v_exp_f32 v200, v152
    v_exp_f32 v201, v153
    v_exp_f32 v202, v154
    v_exp_f32 v203, v155
    v_exp_f32 v204, v156
    v_exp_f32 v205, v157
    v_exp_f32 v206, v158
    v_exp_f32 v207, v159
    v_pk_fma_f32 v[208:209], v[192:193], s[54:55], s[54:55] op_sel:[0,0,1] op_sel_hi:[1,0,1]
    v_pk_fma_f32 v[210:211], v[194:195], s[54:55], s[54:55] op_sel:[0,0,1] op_sel_hi:[1,0,1]
    v_pk_fma_f32 v[212:213], v[196:197], s[54:55], s[54:55] op_sel:[0,0,1] op_sel_hi:[1,0,1]
    v_pk_fma_f32 v[214:215], v[198:199], s[54:55], s[54:55] op_sel:[0,0,1] op_sel_hi:[1,0,1]
    v_pk_fma_f32 v[216:217], v[200:201], s[54:55], s[54:55] op_sel:[0,0,1] op_sel_hi:[1,0,1]
    v_pk_fma_f32 v[218:219], v[202:203], s[54:55], s[54:55] op_sel:[0,0,1] op_sel_hi:[1,0,1]
    v_pk_fma_f32 v[220:221], v[204:205], s[54:55], s[54:55] op_sel:[0,0,1] op_sel_hi:[1,0,1]
    v_pk_fma_f32 v[222:223], v[206:207], s[54:55], s[54:55] op_sel:[0,0,1] op_sel_hi:[1,0,1]
    v_pk_fma_f32 v[208:209], v[192:193], v[208:209], s[54:55] op_sel:[0,0,1] op_sel_hi:[1,1,1]
    v_pk_fma_f32 v[210:211], v[194:195], v[210:211], s[54:55] op_sel:[0,0,1] op_sel_hi:[1,1,1]
    v_pk_fma_f32 v[212:213], v[196:197], v[212:213], s[54:55] op_sel:[0,0,1] op_sel_hi:[1,1,1]
    v_pk_fma_f32 v[214:215], v[198:199], v[214:215], s[54:55] op_sel:[0,0,1] op_sel_hi:[1,1,1]
    v_pk_fma_f32 v[216:217], v[200:201], v[216:217], s[54:55] op_sel:[0,0,1] op_sel_hi:[1,1,1]
    v_pk_fma_f32 v[218:219], v[202:203], v[218:219], s[54:55] op_sel:[0,0,1] op_sel_hi:[1,1,1]
    v_pk_fma_f32 v[220:221], v[204:205], v[220:221], s[54:55] op_sel:[0,0,1] op_sel_hi:[1,1,1]
    v_pk_fma_f32 v[222:223], v[206:207], v[222:223], s[54:55] op_sel:[0,0,1] op_sel_hi:[1,1,1]
    v_rcp_f32 v208, v208
    v_rcp_f32 v209, v209
    v_rcp_f32 v210, v210
    v_rcp_f32 v211, v211
    v_rcp_f32 v212, v212
    v_rcp_f32 v213, v213
    v_rcp_f32 v214, v214
    v_rcp_f32 v215, v215
    v_rcp_f32 v216, v216
    v_rcp_f32 v217, v217
    v_rcp_f32 v218, v218
    v_rcp_f32 v219, v219
    v_rcp_f32 v220, v220
    v_rcp_f32 v221, v221
    v_rcp_f32 v222, v222
    v_rcp_f32 v223, v223
    v_pk_fma_f32 v[144:145], v[144:145], v[208:209], v[144:145] neg_lo:[1,0,0] neg_hi:[1,0,0]
    v_pk_fma_f32 v[146:147], v[146:147], v[210:211], v[146:147] neg_lo:[1,0,0] neg_hi:[1,0,0]
    v_pk_fma_f32 v[148:149], v[148:149], v[212:213], v[148:149] neg_lo:[1,0,0] neg_hi:[1,0,0]
    v_pk_fma_f32 v[150:151], v[150:151], v[214:215], v[150:151] neg_lo:[1,0,0] neg_hi:[1,0,0]
    v_pk_fma_f32 v[152:153], v[152:153], v[216:217], v[152:153] neg_lo:[1,0,0] neg_hi:[1,0,0]
    v_pk_fma_f32 v[154:155], v[154:155], v[218:219], v[154:155] neg_lo:[1,0,0] neg_hi:[1,0,0]
    v_pk_fma_f32 v[156:157], v[156:157], v[220:221], v[156:157] neg_lo:[1,0,0] neg_hi:[1,0,0]
    v_pk_fma_f32 v[158:159], v[158:159], v[222:223], v[158:159] neg_lo:[1,0,0] neg_hi:[1,0,0]
    v_cvt_pk_bf16_f32 v144, v144, v145
    v_cvt_pk_bf16_f32 v145, v146, v147
    v_cvt_pk_bf16_f32 v146, v148, v149
    v_cvt_pk_bf16_f32 v147, v150, v151
    v_cvt_pk_bf16_f32 v148, v152, v153
    v_cvt_pk_bf16_f32 v149, v154, v155
    v_cvt_pk_bf16_f32 v150, v156, v157
    v_cvt_pk_bf16_f32 v151, v158, v159
    buffer_store_dwordx4 v[144:147], v254, s[56:59], s79 offen sc1
    buffer_store_dwordx4 v[148:151], v254, s[56:59], s79 offen offset:2048 sc1
    s_setprio 1
    s_lshl_b32 s14, s86, 6
    v_xor_b32 v216, s14, v244
    v_add_u32 v216, 65536, v216
    v_xor_b32 v217, 64, v216
    v_mov_b32 v218, 134928
    s_mov_b32 s14, 0
    s_nop 1
CP30_P:
    ds_read_b128 v[220:223], v218
    s_add_u32 s14, s14, 1
    s_waitcnt lgkmcnt(0)
    v_min3_u32 v220, v220, v221, v222
    v_min_u32 v220, v220, v223
    s_nop 0
    v_readfirstlane_b32 s15, v220
    s_cmp_gt_u32 s14, 0x80000
    s_nop 0
    s_cselect_b32 s15, 1, s15
    s_cmp_lt_u32 s15, 1
    s_nop 0
    s_cbranch_scc1 CP30_P
    ds_read_b64_tr_b16 v[192:193], v216 offset:8192
    ds_read_b64_tr_b16 v[194:195], v216 offset:8704
    ds_read_b64_tr_b16 v[196:197], v217 offset:8192
    ds_read_b64_tr_b16 v[198:199], v217 offset:8704
    ds_read_b64_tr_b16 v[200:201], v216 offset:10240
    ds_read_b64_tr_b16 v[202:203], v216 offset:10752
    ds_read_b64_tr_b16 v[204:205], v217 offset:10240
    ds_read_b64_tr_b16 v[206:207], v217 offset:10752
    s_waitcnt lgkmcnt(4)
    v_mfma_f32_32x32x16_bf16 v[128:143], v[192:195], v[0:3], 0
    ds_read_b64_tr_b16 v[208:209], v216 offset:12288
    ds_read_b64_tr_b16 v[210:211], v216 offset:12800
    v_mul_f32 v160, v160, v232
    v_exp_f32 v224, v160
    v_mfma_f32_32x32x16_bf16 v[144:159], v[196:199], v[0:3], 0
    ds_read_b64_tr_b16 v[212:213], v217 offset:12288
    ds_read_b64_tr_b16 v[214:215], v217 offset:12800
    v_fma_f32 v227, v224, 0.5, 1.0
    v_mul_f32 v161, v161, v232
    s_waitcnt lgkmcnt(4)
    v_mfma_f32_32x32x16_bf16 v[128:143], v[200:203], v[4:7], v[128:143]
    ds_read_b64_tr_b16 v[192:193], v216 offset:14336
    ds_read_b64_tr_b16 v[194:195], v216 offset:14848
    v_exp_f32 v225, v161
    v_fma_f32 v227, v224, v227, 1.0
    v_mfma_f32_32x32x16_bf16 v[144:159], v[204:207], v[4:7], v[144:159]
    ds_read_b64_tr_b16 v[196:197], v217 offset:14336
    ds_read_b64_tr_b16 v[198:199], v217 offset:14848
    v_rcp_f32 v227, v227
    v_fma_f32 v228, v225, 0.5, 1.0
    v_mul_f32 v162, v162, v232
    s_waitcnt lgkmcnt(4)
    v_mfma_f32_32x32x16_bf16 v[128:143], v[208:211], v[8:11], v[128:143]
    ds_read_b64_tr_b16 v[200:201], v216 offset:16384
    ds_read_b64_tr_b16 v[202:203], v216 offset:16896
    v_exp_f32 v226, v162
    v_fma_f32 v228, v225, v228, 1.0
    v_fma_f32 v160, -v160, v227, v160
    v_mfma_f32_32x32x16_bf16 v[144:159], v[212:215], v[8:11], v[144:159]
    ds_read_b64_tr_b16 v[204:205], v217 offset:16384
    ds_read_b64_tr_b16 v[206:207], v217 offset:16896
    v_rcp_f32 v228, v228
    v_fma_f32 v229, v226, 0.5, 1.0
    v_mul_f32 v163, v163, v232
    s_waitcnt lgkmcnt(4)
    v_mfma_f32_32x32x16_bf16 v[128:143], v[192:195], v[12:15], v[128:143]
    ds_read_b64_tr_b16 v[208:209], v216 offset:18432
    ds_read_b64_tr_b16 v[210:211], v216 offset:18944
    v_exp_f32 v224, v163
    v_fma_f32 v229, v226, v229, 1.0
    v_fma_f32 v161, -v161, v228, v161
    v_mfma_f32_32x32x16_bf16 v[144:159], v[196:199], v[12:15], v[144:159]
    ds_read_b64_tr_b16 v[212:213], v217 offset:18432
    ds_read_b64_tr_b16 v[214:215], v217 offset:18944
    v_rcp_f32 v229, v229
    v_fma_f32 v227, v224, 0.5, 1.0
    v_mul_f32 v164, v164, v232
    v_cvt_pk_bf16_f32 v160, v160, v161
    s_waitcnt lgkmcnt(4)
    v_mfma_f32_32x32x16_bf16 v[128:143], v[200:203], v[16:19], v[128:143]
    ds_read_b64_tr_b16 v[192:193], v216 offset:20480
    ds_read_b64_tr_b16 v[194:195], v216 offset:20992
    v_exp_f32 v225, v164
    v_fma_f32 v227, v224, v227, 1.0
    v_fma_f32 v162, -v162, v229, v162
    v_mfma_f32_32x32x16_bf16 v[144:159], v[204:207], v[16:19], v[144:159]
    ds_read_b64_tr_b16 v[196:197], v217 offset:20480
    ds_read_b64_tr_b16 v[198:199], v217 offset:20992
    v_rcp_f32 v227, v227
    v_fma_f32 v228, v225, 0.5, 1.0
    v_mul_f32 v165, v165, v232
    s_waitcnt lgkmcnt(4)
    v_mfma_f32_32x32x16_bf16 v[128:143], v[208:211], v[20:23], v[128:143]
    ds_read_b64_tr_b16 v[200:201], v216 offset:22528
    ds_read_b64_tr_b16 v[202:203], v216 offset:23040
    v_exp_f32 v226, v165
    v_fma_f32 v228, v225, v228, 1.0
    v_fma_f32 v163, -v163, v227, v163
    v_mfma_f32_32x32x16_bf16 v[144:159], v[212:215], v[20:23], v[144:159]
    ds_read_b64_tr_b16 v[204:205], v217 offset:22528
    ds_read_b64_tr_b16 v[206:207], v217 offset:23040
    v_rcp_f32 v228, v228
    v_fma_f32 v229, v226, 0.5, 1.0
    v_mul_f32 v166, v166, v232
    v_cvt_pk_bf16_f32 v161, v162, v163
    s_waitcnt lgkmcnt(4)
    v_mfma_f32_32x32x16_bf16 v[128:143], v[192:195], v[24:27], v[128:143]
    v_add_u32 v216, -131072, v216
    ds_read_b64_tr_b16 v[208:209], v216 offset:0
    ds_read_b64_tr_b16 v[210:211], v216 offset:512
    v_exp_f32 v224, v166
    v_fma_f32 v229, v226, v229, 1.0
    v_fma_f32 v164, -v164, v228, v164
    v_mfma_f32_32x32x16_bf16 v[144:159], v[196:199], v[24:27], v[144:159]
    v_add_u32 v217, -131072, v217
    ds_read_b64_tr_b16 v[212:213], v217 offset:0
    ds_read_b64_tr_b16 v[214:215], v217 offset:512
    v_rcp_f32 v229, v229
    v_fma_f32 v227, v224, 0.5, 1.0
    v_mul_f32 v167, v167, v232
    s_waitcnt vmcnt(0)
    buffer_store_dword v252, v249, s[56:59], s77 offen offset:0 sc1
    s_waitcnt lgkmcnt(4)
    v_mfma_f32_32x32x16_bf16 v[128:143], v[200:203], v[28:31], v[128:143]
    ds_read_b64_tr_b16 v[192:193], v216 offset:2048
    ds_read_b64_tr_b16 v[194:195], v216 offset:2560
    v_exp_f32 v225, v167
    v_fma_f32 v227, v224, v227, 1.0
    v_fma_f32 v165, -v165, v229, v165
    v_mfma_f32_32x32x16_bf16 v[144:159], v[204:207], v[28:31], v[144:159]
    ds_read_b64_tr_b16 v[196:197], v217 offset:2048
    ds_read_b64_tr_b16 v[198:199], v217 offset:2560
    v_rcp_f32 v227, v227
    v_fma_f32 v228, v225, 0.5, 1.0
    v_mul_f32 v168, v168, v232
    v_cvt_pk_bf16_f32 v162, v164, v165
    s_waitcnt lgkmcnt(4)
    v_mfma_f32_32x32x16_bf16 v[128:143], v[208:211], v[32:35], v[128:143]
    ds_read_b64_tr_b16 v[200:201], v216 offset:4096
    ds_read_b64_tr_b16 v[202:203], v216 offset:4608
    v_exp_f32 v226, v168
    v_fma_f32 v228, v225, v228, 1.0
    v_fma_f32 v166, -v166, v227, v166
    v_mfma_f32_32x32x16_bf16 v[144:159], v[212:215], v[32:35], v[144:159]
    ds_read_b64_tr_b16 v[204:205], v217 offset:4096
    ds_read_b64_tr_b16 v[206:207], v217 offset:4608
    v_rcp_f32 v228, v228
    v_fma_f32 v229, v226, 0.5, 1.0
    v_mul_f32 v169, v169, v232
    s_waitcnt lgkmcnt(4)
    v_mfma_f32_32x32x16_bf16 v[128:143], v[192:195], v[36:39], v[128:143]
    ds_read_b64_tr_b16 v[208:209], v216 offset:6144
    ds_read_b64_tr_b16 v[210:211], v216 offset:6656
    v_exp_f32 v224, v169
    v_fma_f32 v229, v226, v229, 1.0
    v_fma_f32 v167, -v167, v228, v167
    v_mfma_f32_32x32x16_bf16 v[144:159], v[196:199], v[36:39], v[144:159]
    ds_read_b64_tr_b16 v[212:213], v217 offset:6144
    ds_read_b64_tr_b16 v[214:215], v217 offset:6656
    v_rcp_f32 v229, v229
    v_fma_f32 v227, v224, 0.5, 1.0
    v_mul_f32 v170, v170, v232
    v_cvt_pk_bf16_f32 v163, v166, v167
    buffer_store_dwordx4 v[160:163], v254, s[56:59], s48 offen offset:0 sc1
    s_waitcnt lgkmcnt(4)
    v_mfma_f32_32x32x16_bf16 v[128:143], v[200:203], v[40:43], v[128:143]
    ds_read_b64_tr_b16 v[192:193], v216 offset:8192
    ds_read_b64_tr_b16 v[194:195], v216 offset:8704
    v_exp_f32 v225, v170
    v_fma_f32 v227, v224, v227, 1.0
    v_fma_f32 v168, -v168, v229, v168
    v_mfma_f32_32x32x16_bf16 v[144:159], v[204:207], v[40:43], v[144:159]
    ds_read_b64_tr_b16 v[196:197], v217 offset:8192
    ds_read_b64_tr_b16 v[198:199], v217 offset:8704
    v_rcp_f32 v227, v227
    v_fma_f32 v228, v225, 0.5, 1.0
    v_mul_f32 v171, v171, v232
    s_waitcnt lgkmcnt(4)
    v_mfma_f32_32x32x16_bf16 v[128:143], v[208:211], v[44:47], v[128:143]
    ds_read_b64_tr_b16 v[200:201], v216 offset:10240
    ds_read_b64_tr_b16 v[202:203], v216 offset:10752
    v_exp_f32 v226, v171
    v_fma_f32 v228, v225, v228, 1.0
    v_fma_f32 v169, -v169, v227, v169
    v_mfma_f32_32x32x16_bf16 v[144:159], v[212:215], v[44:47], v[144:159]
    ds_read_b64_tr_b16 v[204:205], v217 offset:10240
    ds_read_b64_tr_b16 v[206:207], v217 offset:10752
    v_rcp_f32 v228, v228
    v_fma_f32 v229, v226, 0.5, 1.0
    v_mul_f32 v172, v172, v232
    v_cvt_pk_bf16_f32 v164, v168, v169
    s_waitcnt lgkmcnt(4)
    v_mfma_f32_32x32x16_bf16 v[128:143], v[192:195], v[48:51], v[128:143]
    ds_read_b64_tr_b16 v[208:209], v216 offset:12288
    ds_read_b64_tr_b16 v[210:211], v216 offset:12800
    v_exp_f32 v224, v172
    v_fma_f32 v229, v226, v229, 1.0
    v_fma_f32 v170, -v170, v228, v170
    v_mfma_f32_32x32x16_bf16 v[144:159], v[196:199], v[48:51], v[144:159]
    ds_read_b64_tr_b16 v[212:213], v217 offset:12288
    ds_read_b64_tr_b16 v[214:215], v217 offset:12800
    v_rcp_f32 v229, v229
    v_fma_f32 v227, v224, 0.5, 1.0
    v_mul_f32 v173, v173, v232
    s_waitcnt lgkmcnt(4)
    v_mfma_f32_32x32x16_bf16 v[128:143], v[200:203], v[52:55], v[128:143]
    ds_read_b64_tr_b16 v[192:193], v216 offset:14336
    ds_read_b64_tr_b16 v[194:195], v216 offset:14848
    v_exp_f32 v225, v173
    v_fma_f32 v227, v224, v227, 1.0
    v_fma_f32 v171, -v171, v229, v171
    v_mfma_f32_32x32x16_bf16 v[144:159], v[204:207], v[52:55], v[144:159]
    ds_read_b64_tr_b16 v[196:197], v217 offset:14336
    ds_read_b64_tr_b16 v[198:199], v217 offset:14848
    v_rcp_f32 v227, v227
    v_fma_f32 v228, v225, 0.5, 1.0
    v_mul_f32 v174, v174, v232
    v_cvt_pk_bf16_f32 v165, v170, v171
    s_waitcnt lgkmcnt(4)
    v_mfma_f32_32x32x16_bf16 v[128:143], v[208:211], v[56:59], v[128:143]
    v_add_u32 v216, 65536, v216
    ds_read_b64_tr_b16 v[200:201], v216 offset:0
    ds_read_b64_tr_b16 v[202:203], v216 offset:512
    v_exp_f32 v226, v174
    v_fma_f32 v228, v225, v228, 1.0
    v_fma_f32 v172, -v172, v227, v172
    v_mfma_f32_32x32x16_bf16 v[144:159], v[212:215], v[56:59], v[144:159]
    v_add_u32 v217, 65536, v217
    ds_read_b64_tr_b16 v[204:205], v217 offset:0
    ds_read_b64_tr_b16 v[206:207], v217 offset:512
    v_rcp_f32 v228, v228
    v_fma_f32 v229, v226, 0.5, 1.0
    v_mul_f32 v175, v175, v232
    s_waitcnt lgkmcnt(4)
    v_mfma_f32_32x32x16_bf16 v[128:143], v[192:195], v[60:63], v[128:143]
    ds_read_b64_tr_b16 v[208:209], v216 offset:2048
    ds_read_b64_tr_b16 v[210:211], v216 offset:2560
    v_exp_f32 v224, v175
    v_fma_f32 v229, v226, v229, 1.0
    v_fma_f32 v173, -v173, v228, v173
    v_mfma_f32_32x32x16_bf16 v[144:159], v[196:199], v[60:63], v[144:159]
    ds_read_b64_tr_b16 v[212:213], v217 offset:2048
    ds_read_b64_tr_b16 v[214:215], v217 offset:2560
    v_rcp_f32 v229, v229
    v_fma_f32 v227, v224, 0.5, 1.0
    v_mul_f32 v176, v176, v234
    v_cvt_pk_bf16_f32 v166, v172, v173
    s_waitcnt lgkmcnt(4)
    v_mfma_f32_32x32x16_bf16 v[128:143], v[200:203], v[64:67], v[128:143]
    ds_read_b64_tr_b16 v[192:193], v216 offset:4096
    ds_read_b64_tr_b16 v[194:195], v216 offset:4608
    v_exp_f32 v225, v176
    v_fma_f32 v227, v224, v227, 1.0
    v_fma_f32 v174, -v174, v229, v174
    v_mfma_f32_32x32x16_bf16 v[144:159], v[204:207], v[64:67], v[144:159]
    ds_read_b64_tr_b16 v[196:197], v217 offset:4096
    ds_read_b64_tr_b16 v[198:199], v217 offset:4608
    v_rcp_f32 v227, v227
    v_fma_f32 v228, v225, 0.5, 1.0
    v_mul_f32 v177, v177, v234
    s_waitcnt lgkmcnt(4)
    v_mfma_f32_32x32x16_bf16 v[128:143], v[208:211], v[68:71], v[128:143]
    ds_read_b64_tr_b16 v[200:201], v216 offset:6144
    ds_read_b64_tr_b16 v[202:203], v216 offset:6656
    v_exp_f32 v226, v177
    v_fma_f32 v228, v225, v228, 1.0
    v_fma_f32 v175, -v175, v227, v175
    v_mfma_f32_32x32x16_bf16 v[144:159], v[212:215], v[68:71], v[144:159]
    ds_read_b64_tr_b16 v[204:205], v217 offset:6144
    ds_read_b64_tr_b16 v[206:207], v217 offset:6656
    v_rcp_f32 v228, v228
    v_fma_f32 v229, v226, 0.5, 1.0
    v_mul_f32 v178, v178, v234
    v_cvt_pk_bf16_f32 v167, v174, v175
    buffer_store_dwordx4 v[164:167], v254, s[56:59], s48 offen offset:2048 sc1
    s_waitcnt lgkmcnt(4)
    v_mfma_f32_32x32x16_bf16 v[128:143], v[192:195], v[72:75], v[128:143]
    ds_read_b64_tr_b16 v[208:209], v216 offset:8192
    ds_read_b64_tr_b16 v[210:211], v216 offset:8704
    v_exp_f32 v224, v178
    v_fma_f32 v229, v226, v229, 1.0
    v_fma_f32 v176, -v176, v228, v176
    v_mfma_f32_32x32x16_bf16 v[144:159], v[196:199], v[72:75], v[144:159]
    ds_read_b64_tr_b16 v[212:213], v217 offset:8192
    ds_read_b64_tr_b16 v[214:215], v217 offset:8704
    v_rcp_f32 v229, v229
    v_fma_f32 v227, v224, 0.5, 1.0
    v_mul_f32 v179, v179, v234
    s_waitcnt lgkmcnt(4)
    v_mfma_f32_32x32x16_bf16 v[128:143], v[200:203], v[76:79], v[128:143]
    ds_read_b64_tr_b16 v[192:193], v216 offset:10240
    ds_read_b64_tr_b16 v[194:195], v216 offset:10752
    v_exp_f32 v225, v179
    v_fma_f32 v227, v224, v227, 1.0
    v_fma_f32 v177, -v177, v229, v177
    v_mfma_f32_32x32x16_bf16 v[144:159], v[204:207], v[76:79], v[144:159]
    ds_read_b64_tr_b16 v[196:197], v217 offset:10240
    ds_read_b64_tr_b16 v[198:199], v217 offset:10752
    v_rcp_f32 v227, v227
    v_fma_f32 v228, v225, 0.5, 1.0
    v_mul_f32 v180, v180, v234
    v_cvt_pk_bf16_f32 v176, v176, v177
    s_waitcnt lgkmcnt(4)
    v_mfma_f32_32x32x16_bf16 v[128:143], v[208:211], v[80:83], v[128:143]
    ds_read_b64_tr_b16 v[200:201], v216 offset:12288
    ds_read_b64_tr_b16 v[202:203], v216 offset:12800
    v_exp_f32 v226, v180
    v_fma_f32 v228, v225, v228, 1.0
    v_fma_f32 v178, -v178, v227, v178
    v_mfma_f32_32x32x16_bf16 v[144:159], v[212:215], v[80:83], v[144:159]
    ds_read_b64_tr_b16 v[204:205], v217 offset:12288
    ds_read_b64_tr_b16 v[206:207], v217 offset:12800
    v_rcp_f32 v228, v228
    v_fma_f32 v229, v226, 0.5, 1.0
    v_mul_f32 v181, v181, v234
    s_waitcnt lgkmcnt(4)
    v_mfma_f32_32x32x16_bf16 v[128:143], v[192:195], v[84:87], v[128:143]
    ds_read_b64_tr_b16 v[208:209], v216 offset:14336
    ds_read_b64_tr_b16 v[210:211], v216 offset:14848
    v_exp_f32 v224, v181
    v_fma_f32 v229, v226, v229, 1.0
    v_fma_f32 v179, -v179, v228, v179
    v_mfma_f32_32x32x16_bf16 v[144:159], v[196:199], v[84:87], v[144:159]
    ds_read_b64_tr_b16 v[212:213], v217 offset:14336
    ds_read_b64_tr_b16 v[214:215], v217 offset:14848
    v_rcp_f32 v229, v229
    v_fma_f32 v227, v224, 0.5, 1.0
    v_mul_f32 v182, v182, v234
    v_cvt_pk_bf16_f32 v177, v178, v179
    s_waitcnt lgkmcnt(4)
    v_mfma_f32_32x32x16_bf16 v[128:143], v[200:203], v[88:91], v[128:143]
    v_add_u32 v216, -65536, v216
    ds_read_b64_tr_b16 v[192:193], v216 offset:16384
    ds_read_b64_tr_b16 v[194:195], v216 offset:16896
    v_exp_f32 v225, v182
    v_fma_f32 v227, v224, v227, 1.0
    v_fma_f32 v180, -v180, v229, v180
    v_mfma_f32_32x32x16_bf16 v[144:159], v[204:207], v[88:91], v[144:159]
    v_add_u32 v217, -65536, v217
    ds_read_b64_tr_b16 v[196:197], v217 offset:16384
    ds_read_b64_tr_b16 v[198:199], v217 offset:16896
    v_rcp_f32 v227, v227
    v_fma_f32 v228, v225, 0.5, 1.0
    v_mul_f32 v183, v183, v234
    s_waitcnt lgkmcnt(4)
    v_mfma_f32_32x32x16_bf16 v[128:143], v[208:211], v[92:95], v[128:143]
    ds_read_b64_tr_b16 v[200:201], v216 offset:18432
    ds_read_b64_tr_b16 v[202:203], v216 offset:18944
    v_exp_f32 v226, v183
    v_fma_f32 v228, v225, v228, 1.0
    v_fma_f32 v181, -v181, v227, v181
    v_mfma_f32_32x32x16_bf16 v[144:159], v[212:215], v[92:95], v[144:159]
    ds_read_b64_tr_b16 v[204:205], v217 offset:18432
    ds_read_b64_tr_b16 v[206:207], v217 offset:18944
    v_rcp_f32 v228, v228
    v_fma_f32 v229, v226, 0.5, 1.0
    v_mul_f32 v184, v184, v234
    v_cvt_pk_bf16_f32 v178, v180, v181
    s_waitcnt lgkmcnt(4)
    v_mfma_f32_32x32x16_bf16 v[128:143], v[192:195], v[96:99], v[128:143]
    ds_read_b64_tr_b16 v[208:209], v216 offset:20480
    ds_read_b64_tr_b16 v[210:211], v216 offset:20992
    v_mov_b32 v1, 0
    v_exp_f32 v224, v184
    v_fma_f32 v229, v226, v229, 1.0
    v_fma_f32 v182, -v182, v228, v182
    v_mfma_f32_32x32x16_bf16 v[144:159], v[196:199], v[96:99], v[144:159]
    ds_read_b64_tr_b16 v[212:213], v217 offset:20480
    ds_read_b64_tr_b16 v[214:215], v217 offset:20992
    v_mov_b32 v2, 0
    v_rcp_f32 v229, v229
    v_fma_f32 v227, v224, 0.5, 1.0
    v_mul_f32 v185, v185, v234
    s_waitcnt lgkmcnt(4)
    v_mfma_f32_32x32x16_bf16 v[128:143], v[200:203], v[100:103], v[128:143]
    ds_read_b64_tr_b16 v[192:193], v216 offset:22528
    ds_read_b64_tr_b16 v[194:195], v216 offset:23040
    v_mov_b32 v3, 0
    v_exp_f32 v225, v185
    v_fma_f32 v227, v224, v227, 1.0
    v_fma_f32 v183, -v183, v229, v183
    v_mfma_f32_32x32x16_bf16 v[144:159], v[204:207], v[100:103], v[144:159]
    ds_read_b64_tr_b16 v[196:197], v217 offset:22528
    ds_read_b64_tr_b16 v[198:199], v217 offset:23040
    v_mov_b32 v5, 0
    v_rcp_f32 v227, v227
    v_fma_f32 v228, v225, 0.5, 1.0
    v_mul_f32 v186, v186, v234
    v_cvt_pk_bf16_f32 v179, v182, v183
    buffer_store_dwordx4 v[176:179], v254, s[56:59], s49 offen offset:0 sc1
    s_waitcnt lgkmcnt(4)
    v_mfma_f32_32x32x16_bf16 v[128:143], v[208:211], v[104:107], v[128:143]
    ds_read_b64_tr_b16 v[200:201], v216 offset:24576
    ds_read_b64_tr_b16 v[202:203], v216 offset:25088
    v_mov_b32 v6, 0
    v_exp_f32 v226, v186
    v_fma_f32 v228, v225, v228, 1.0
    v_fma_f32 v184, -v184, v227, v184
    v_mfma_f32_32x32x16_bf16 v[144:159], v[212:215], v[104:107], v[144:159]
    ds_read_b64_tr_b16 v[204:205], v217 offset:24576
    ds_read_b64_tr_b16 v[206:207], v217 offset:25088
    v_mov_b32 v7, 0
    v_rcp_f32 v228, v228
    v_fma_f32 v229, v226, 0.5, 1.0
    v_mul_f32 v187, v187, v234
    s_waitcnt lgkmcnt(4)
    v_mfma_f32_32x32x16_bf16 v[128:143], v[192:195], v[108:111], v[128:143]
    ds_read_b64_tr_b16 v[208:209], v216 offset:26624
    ds_read_b64_tr_b16 v[210:211], v216 offset:27136
    v_mov_b32 v9, 0
    v_exp_f32 v224, v187
    v_fma_f32 v229, v226, v229, 1.0
    v_fma_f32 v185, -v185, v228, v185
    v_mfma_f32_32x32x16_bf16 v[144:159], v[196:199], v[108:111], v[144:159]
    ds_read_b64_tr_b16 v[212:213], v217 offset:26624
    ds_read_b64_tr_b16 v[214:215], v217 offset:27136
    v_mov_b32 v10, 0
    v_rcp_f32 v229, v229
    v_fma_f32 v227, v224, 0.5, 1.0
    v_mul_f32 v188, v188, v234
    v_cvt_pk_bf16_f32 v180, v184, v185
    s_waitcnt lgkmcnt(4)
    v_mfma_f32_32x32x16_bf16 v[128:143], v[200:203], v[112:115], v[128:143]
    ds_read_b64_tr_b16 v[192:193], v216 offset:28672
    ds_read_b64_tr_b16 v[194:195], v216 offset:29184
    v_mov_b32 v11, 0
    v_exp_f32 v225, v188
    v_fma_f32 v227, v224, v227, 1.0
    v_fma_f32 v186, -v186, v229, v186
    v_mfma_f32_32x32x16_bf16 v[144:159], v[204:207], v[112:115], v[144:159]
    ds_read_b64_tr_b16 v[196:197], v217 offset:28672
    ds_read_b64_tr_b16 v[198:199], v217 offset:29184
    v_rcp_f32 v227, v227
    v_fma_f32 v228, v225, 0.5, 1.0
    v_mul_f32 v189, v189, v234
    s_waitcnt lgkmcnt(4)
    v_mfma_f32_32x32x16_bf16 v[128:143], v[208:211], v[116:119], v[128:143]
    ds_read_b64_tr_b16 v[200:201], v216 offset:30720
    ds_read_b64_tr_b16 v[202:203], v216 offset:31232
    v_exp_f32 v226, v189
    v_fma_f32 v228, v225, v228, 1.0
    v_fma_f32 v187, -v187, v227, v187
    v_mfma_f32_32x32x16_bf16 v[144:159], v[212:215], v[116:119], v[144:159]
    ds_read_b64_tr_b16 v[204:205], v217 offset:30720
    ds_read_b64_tr_b16 v[206:207], v217 offset:31232
    v_rcp_f32 v228, v228
    v_fma_f32 v229, v226, 0.5, 1.0
    v_mul_f32 v190, v190, v234
    v_cvt_pk_bf16_f32 v181, v186, v187
    s_waitcnt lgkmcnt(4)
    v_mfma_f32_32x32x16_bf16 v[128:143], v[192:195], v[120:123], v[128:143]
    ds_read_b32 v0, v245 offset:512
    ds_read_b32 v4, v245 offset:1280
    ds_read_b32 v8, v246
    v_exp_f32 v224, v190
    v_fma_f32 v229, v226, v229, 1.0
    v_fma_f32 v188, -v188, v228, v188
    v_mfma_f32_32x32x16_bf16 v[144:159], v[196:199], v[120:123], v[144:159]
    ds_read_b64_tr_b16 v[16:17], v248 offset:0
    ds_read_b64_tr_b16 v[18:19], v248 offset:256
    ds_read_b64_tr_b16 v[20:21], v248 offset:512
    v_rcp_f32 v229, v229
    v_fma_f32 v227, v224, 0.5, 1.0
    v_mul_f32 v191, v191, v234
    s_waitcnt lgkmcnt(6)
    v_mfma_f32_32x32x16_bf16 v[128:143], v[200:203], v[124:127], v[128:143]
    ds_read_b64_tr_b16 v[22:23], v248 offset:768
    ds_read_b64_tr_b16 v[24:25], v248 offset:1024
    ds_read_b64_tr_b16 v[26:27], v248 offset:1280
    v_exp_f32 v225, v191
    v_fma_f32 v227, v224, v227, 1.0
    v_fma_f32 v189, -v189, v229, v189
    v_mfma_f32_32x32x16_bf16 v[144:159], v[204:207], v[124:127], v[144:159]
    ds_read_b64_tr_b16 v[28:29], v248 offset:1536
    ds_read_b64_tr_b16 v[30:31], v248 offset:1792
    v_rcp_f32 v227, v227
    v_fma_f32 v228, v225, 0.5, 1.0
    v_cvt_pk_bf16_f32 v182, v188, v189
    s_lshl_b32 s14, s84, 2
    s_add_u32 s14, s14, 134944
    v_mov_b32 v216, s14
    v_mov_b32 v217, 2
    s_waitcnt lgkmcnt(8)
    ds_write_b32 v216, v217
    v_mfma_f32_32x32x16_bf16 v[128:143], v[0:3], v[8:11], v[128:143]
    v_mfma_f32_32x32x16_bf16 v[144:159], v[4:7], v[8:11], v[144:159]
    v_fma_f32 v228, v225, v228, 1.0
    v_fma_f32 v190, -v190, v227, v190
    v_rcp_f32 v228, v228
    s_nop 0
    v_fma_f32 v191, -v191, v228, v191
    v_cvt_pk_bf16_f32 v183, v190, v191
    buffer_store_dwordx4 v[180:183], v254, s[56:59], s49 offen offset:2048 sc1
    s_setprio 1
    v_bfe_u32 v12, v255, 2, 1
    v_mul_u32_u24 v12, 0x8000, v12
    v_lshl_or_b32 v12, v12, 16, v12
    s_waitcnt lgkmcnt(1)
    v_xor_b32 v16, v12, v16
    v_xor_b32 v17, v12, v17
    v_xor_b32 v18, v12, v18
    v_xor_b32 v19, v12, v19
    v_xor_b32 v20, v12, v20
    v_xor_b32 v21, v12, v21
    v_xor_b32 v22, v12, v22
    v_xor_b32 v23, v12, v23
    v_xor_b32 v24, v12, v24
    v_xor_b32 v25, v12, v25
    v_xor_b32 v26, v12, v26
    v_xor_b32 v27, v12, v27
    v_xor_b32 v28, v12, v28
    v_xor_b32 v29, v12, v29
    v_xor_b32 v30, v12, v30
    v_xor_b32 v31, v12, v31
    v_pk_mul_f32 v[128:129], v[128:129], v[236:237] op_sel_hi:[1,0]
    v_pk_mul_f32 v[130:131], v[130:131], v[236:237] op_sel_hi:[1,0]
    v_pk_mul_f32 v[132:133], v[132:133], v[236:237] op_sel_hi:[1,0]
    v_pk_mul_f32 v[134:135], v[134:135], v[236:237] op_sel_hi:[1,0]
    v_pk_mul_f32 v[136:137], v[136:137], v[236:237] op_sel_hi:[1,0]
    v_pk_mul_f32 v[138:139], v[138:139], v[236:237] op_sel_hi:[1,0]
    v_pk_mul_f32 v[140:141], v[140:141], v[236:237] op_sel_hi:[1,0]
    v_pk_mul_f32 v[142:143], v[142:143], v[236:237] op_sel_hi:[1,0]
    v_cvt_pk_bf16_f32 v128, v128, v129
    v_cvt_pk_bf16_f32 v129, v130, v131
    v_cvt_pk_bf16_f32 v130, v132, v133
    v_cvt_pk_bf16_f32 v131, v134, v135
    v_cvt_pk_bf16_f32 v132, v136, v137
    v_cvt_pk_bf16_f32 v133, v138, v139
    v_cvt_pk_bf16_f32 v134, v140, v141
    v_cvt_pk_bf16_f32 v135, v142, v143
    v_mfma_f32_32x32x16_bf16 v[32:47], v[16:19], v[128:131], 0
    s_nop 0
    v_mfma_f32_32x32x16_bf16 v[48:63], v[20:23], v[132:135], 0
    v_pk_mul_f32 v[144:145], v[144:145], v[236:237] op_sel_hi:[1,0]
    v_pk_mul_f32 v[146:147], v[146:147], v[236:237] op_sel_hi:[1,0]
    v_pk_mul_f32 v[148:149], v[148:149], v[236:237] op_sel_hi:[1,0]
    v_pk_mul_f32 v[150:151], v[150:151], v[236:237] op_sel_hi:[1,0]
    v_pk_mul_f32 v[152:153], v[152:153], v[236:237] op_sel_hi:[1,0]
    v_pk_mul_f32 v[154:155], v[154:155], v[236:237] op_sel_hi:[1,0]
    v_pk_mul_f32 v[156:157], v[156:157], v[236:237] op_sel_hi:[1,0]
    v_pk_mul_f32 v[158:159], v[158:159], v[236:237] op_sel_hi:[1,0]
    v_cvt_pk_bf16_f32 v144, v144, v145
    v_cvt_pk_bf16_f32 v145, v146, v147
    v_cvt_pk_bf16_f32 v146, v148, v149
    v_cvt_pk_bf16_f32 v147, v150, v151
    v_cvt_pk_bf16_f32 v148, v152, v153
    v_cvt_pk_bf16_f32 v149, v154, v155
    v_cvt_pk_bf16_f32 v150, v156, v157
    v_cvt_pk_bf16_f32 v151, v158, v159
    v_mfma_f32_32x32x16_bf16 v[64:79], v[24:27], v[144:147], 0
    s_nop 0
    v_mfma_f32_32x32x16_bf16 v[80:95], v[28:31], v[148:151], 0
    v_and_b32 v228, 31, v255
    v_min_u32 v228, 16, v228
    v_lshrrev_b32 v229, 5, v255
    v_mul_u32_u24 v229, 17, v229
    v_add_lshl_u32 v228, v228, v229, 4
    v_add_u32 v228, 155648, v228
    v_mov_b32 v229, 134992
    s_lshl_b32 s14, s84, 2
    v_add_u32 v230, s14, v229
    s_add_u32 s78, s82, 4096
    v_max3_f32 v12, v32, v33, v34
    v_max3_f32 v224, v48, v49, v50
    v_max3_f32 v13, v35, v36, v37
    v_max3_f32 v225, v51, v52, v53
    v_max3_f32 v14, v38, v39, v40
    v_max3_f32 v226, v54, v55, v56
    v_max3_f32 v15, v41, v42, v43
    v_max3_f32 v227, v57, v58, v59
    v_max3_f32 v12, v12, v44, v45
    v_max3_f32 v224, v224, v60, v61
    v_max3_f32 v13, v13, v46, v47
    v_max3_f32 v225, v225, v62, v63
    v_max3_f32 v12, v12, v13, v14
    v_max3_f32 v224, v224, v225, v226
    v_max_f32 v12, v12, v15
    v_max_f32 v224, v224, v227
    v_mul_f32 v12, 0xbfb8aa3b, v12
    v_mul_f32 v224, 0xbfb8aa3b, v224
    v_pk_fma_f32 v[32:33], v[32:33], s[52:53], v[12:13] op_sel_hi:[1,1,0]
    v_pk_fma_f32 v[48:49], v[48:49], s[52:53], v[224:225] op_sel_hi:[1,1,0]
    v_pk_fma_f32 v[34:35], v[34:35], s[52:53], v[12:13] op_sel_hi:[1,1,0]
    v_pk_fma_f32 v[50:51], v[50:51], s[52:53], v[224:225] op_sel_hi:[1,1,0]
    v_pk_fma_f32 v[36:37], v[36:37], s[52:53], v[12:13] op_sel_hi:[1,1,0]
    v_pk_fma_f32 v[52:53], v[52:53], s[52:53], v[224:225] op_sel_hi:[1,1,0]
    v_pk_fma_f32 v[38:39], v[38:39], s[52:53], v[12:13] op_sel_hi:[1,1,0]
    v_pk_fma_f32 v[54:55], v[54:55], s[52:53], v[224:225] op_sel_hi:[1,1,0]
    v_pk_fma_f32 v[40:41], v[40:41], s[52:53], v[12:13] op_sel_hi:[1,1,0]
    v_pk_fma_f32 v[56:57], v[56:57], s[52:53], v[224:225] op_sel_hi:[1,1,0]
    v_pk_fma_f32 v[42:43], v[42:43], s[52:53], v[12:13] op_sel_hi:[1,1,0]
    v_pk_fma_f32 v[58:59], v[58:59], s[52:53], v[224:225] op_sel_hi:[1,1,0]
    v_pk_fma_f32 v[44:45], v[44:45], s[52:53], v[12:13] op_sel_hi:[1,1,0]
    v_pk_fma_f32 v[60:61], v[60:61], s[52:53], v[224:225] op_sel_hi:[1,1,0]
    v_pk_fma_f32 v[46:47], v[46:47], s[52:53], v[12:13] op_sel_hi:[1,1,0]
    v_pk_fma_f32 v[62:63], v[62:63], s[52:53], v[224:225] op_sel_hi:[1,1,0]
    v_exp_f32 v32, v32
    v_exp_f32 v48, v48
    v_exp_f32 v33, v33
    v_exp_f32 v49, v49
    v_exp_f32 v34, v34
    v_exp_f32 v50, v50
    v_exp_f32 v35, v35
    v_exp_f32 v51, v51
    v_exp_f32 v36, v36
    v_exp_f32 v52, v52
    v_exp_f32 v37, v37
    v_exp_f32 v53, v53
    v_exp_f32 v38, v38
    v_exp_f32 v54, v54
    v_exp_f32 v39, v39
    v_exp_f32 v55, v55
    v_exp_f32 v40, v40
    v_exp_f32 v56, v56
    v_exp_f32 v41, v41
    v_exp_f32 v57, v57
    v_exp_f32 v42, v42
    v_exp_f32 v58, v58
    v_exp_f32 v43, v43
    v_exp_f32 v59, v59
    v_exp_f32 v44, v44
    v_exp_f32 v60, v60
    v_exp_f32 v45, v45
    v_exp_f32 v61, v61
    v_exp_f32 v46, v46
    v_exp_f32 v62, v62
    v_exp_f32 v47, v47
    v_exp_f32 v63, v63
    v_pk_add_f32 v[12:13], v[32:33], v[34:35]
    v_pk_add_f32 v[224:225], v[48:49], v[50:51]
    v_pk_add_f32 v[14:15], v[36:37], v[38:39]
    v_pk_add_f32 v[226:227], v[52:53], v[54:55]
    v_pk_add_f32 v[12:13], v[12:13], v[40:41]
    v_pk_add_f32 v[224:225], v[224:225], v[56:57]
    v_pk_add_f32 v[14:15], v[14:15], v[42:43]
    v_pk_add_f32 v[226:227], v[226:227], v[58:59]
    v_pk_add_f32 v[12:13], v[12:13], v[44:45]
    v_pk_add_f32 v[224:225], v[224:225], v[60:61]
    v_pk_add_f32 v[14:15], v[14:15], v[46:47]
    v_pk_add_f32 v[226:227], v[226:227], v[62:63]
    v_pk_add_f32 v[12:13], v[12:13], v[14:15]
    v_pk_add_f32 v[224:225], v[224:225], v[226:227]
    v_add_f32 v12, v12, v13
    v_add_f32 v224, v224, v225
    v_rcp_f32 v12, v12
    v_rcp_f32 v224, v224
    v_pk_mul_f32 v[32:33], v[32:33], v[12:13] op_sel_hi:[1,0]
    v_pk_mul_f32 v[48:49], v[48:49], v[224:225] op_sel_hi:[1,0]
    v_pk_mul_f32 v[34:35], v[34:35], v[12:13] op_sel_hi:[1,0]
    v_pk_mul_f32 v[50:51], v[50:51], v[224:225] op_sel_hi:[1,0]
    v_pk_mul_f32 v[36:37], v[36:37], v[12:13] op_sel_hi:[1,0]
    v_pk_mul_f32 v[52:53], v[52:53], v[224:225] op_sel_hi:[1,0]
    v_pk_mul_f32 v[38:39], v[38:39], v[12:13] op_sel_hi:[1,0]
    v_pk_mul_f32 v[54:55], v[54:55], v[224:225] op_sel_hi:[1,0]
    v_pk_mul_f32 v[40:41], v[40:41], v[12:13] op_sel_hi:[1,0]
    v_pk_mul_f32 v[56:57], v[56:57], v[224:225] op_sel_hi:[1,0]
    v_pk_mul_f32 v[42:43], v[42:43], v[12:13] op_sel_hi:[1,0]
    v_pk_mul_f32 v[58:59], v[58:59], v[224:225] op_sel_hi:[1,0]
    v_pk_mul_f32 v[44:45], v[44:45], v[12:13] op_sel_hi:[1,0]
    v_pk_mul_f32 v[60:61], v[60:61], v[224:225] op_sel_hi:[1,0]
    v_pk_mul_f32 v[46:47], v[46:47], v[12:13] op_sel_hi:[1,0]
    v_pk_mul_f32 v[62:63], v[62:63], v[224:225] op_sel_hi:[1,0]
    v_cvt_pk_bf16_f32 v96, v32, v33
    v_cvt_pk_bf16_f32 v104, v48, v49
    v_cvt_pk_bf16_f32 v97, v34, v35
    v_cvt_pk_bf16_f32 v105, v50, v51
    v_cvt_pk_bf16_f32 v98, v36, v37
    v_cvt_pk_bf16_f32 v106, v52, v53
    v_cvt_pk_bf16_f32 v99, v38, v39
    v_cvt_pk_bf16_f32 v107, v54, v55
    v_cvt_pk_bf16_f32 v100, v40, v41
    v_cvt_pk_bf16_f32 v108, v56, v57
    v_cvt_pk_bf16_f32 v101, v42, v43
    v_cvt_pk_bf16_f32 v109, v58, v59
    v_cvt_pk_bf16_f32 v102, v44, v45
    v_cvt_pk_bf16_f32 v110, v60, v61
    v_cvt_pk_bf16_f32 v103, v46, v47
    v_cvt_pk_bf16_f32 v111, v62, v63
    s_waitcnt vmcnt(0)
    buffer_store_dword v252, v249, s[56:59], s77 offen offset:16 sc1
    v_max3_f32 v12, v64, v65, v66
    v_max3_f32 v224, v80, v81, v82
    v_max3_f32 v13, v67, v68, v69
    v_max3_f32 v225, v83, v84, v85
    v_max3_f32 v14, v70, v71, v72
    v_max3_f32 v226, v86, v87, v88
    v_max3_f32 v15, v73, v74, v75
    v_max3_f32 v227, v89, v90, v91
    v_max3_f32 v12, v12, v76, v77
    v_max3_f32 v224, v224, v92, v93
    v_max3_f32 v13, v13, v78, v79
    v_max3_f32 v225, v225, v94, v95
    v_max3_f32 v12, v12, v13, v14
    v_max3_f32 v224, v224, v225, v226
    v_max_f32 v12, v12, v15
    v_max_f32 v224, v224, v227
    v_mul_f32 v12, 0xbfb8aa3b, v12
    v_mul_f32 v224, 0xbfb8aa3b, v224
    v_pk_fma_f32 v[64:65], v[64:65], s[52:53], v[12:13] op_sel_hi:[1,1,0]
    v_pk_fma_f32 v[80:81], v[80:81], s[52:53], v[224:225] op_sel_hi:[1,1,0]
    v_pk_fma_f32 v[66:67], v[66:67], s[52:53], v[12:13] op_sel_hi:[1,1,0]
    v_pk_fma_f32 v[82:83], v[82:83], s[52:53], v[224:225] op_sel_hi:[1,1,0]
    v_pk_fma_f32 v[68:69], v[68:69], s[52:53], v[12:13] op_sel_hi:[1,1,0]
    v_pk_fma_f32 v[84:85], v[84:85], s[52:53], v[224:225] op_sel_hi:[1,1,0]
    v_pk_fma_f32 v[70:71], v[70:71], s[52:53], v[12:13] op_sel_hi:[1,1,0]
    v_pk_fma_f32 v[86:87], v[86:87], s[52:53], v[224:225] op_sel_hi:[1,1,0]
    v_pk_fma_f32 v[72:73], v[72:73], s[52:53], v[12:13] op_sel_hi:[1,1,0]
    v_pk_fma_f32 v[88:89], v[88:89], s[52:53], v[224:225] op_sel_hi:[1,1,0]
    v_pk_fma_f32 v[74:75], v[74:75], s[52:53], v[12:13] op_sel_hi:[1,1,0]
    v_pk_fma_f32 v[90:91], v[90:91], s[52:53], v[224:225] op_sel_hi:[1,1,0]
    v_pk_fma_f32 v[76:77], v[76:77], s[52:53], v[12:13] op_sel_hi:[1,1,0]
    v_pk_fma_f32 v[92:93], v[92:93], s[52:53], v[224:225] op_sel_hi:[1,1,0]
    v_pk_fma_f32 v[78:79], v[78:79], s[52:53], v[12:13] op_sel_hi:[1,1,0]
    v_pk_fma_f32 v[94:95], v[94:95], s[52:53], v[224:225] op_sel_hi:[1,1,0]
    v_exp_f32 v64, v64
    v_exp_f32 v80, v80
    v_exp_f32 v65, v65
    v_exp_f32 v81, v81
    v_exp_f32 v66, v66
    v_exp_f32 v82, v82
    v_exp_f32 v67, v67
    v_exp_f32 v83, v83
    v_exp_f32 v68, v68
    v_exp_f32 v84, v84
    v_exp_f32 v69, v69
    v_exp_f32 v85, v85
    v_exp_f32 v70, v70
    v_exp_f32 v86, v86
    v_exp_f32 v71, v71
    v_exp_f32 v87, v87
    v_exp_f32 v72, v72
    v_exp_f32 v88, v88
    v_exp_f32 v73, v73
    v_exp_f32 v89, v89
    v_exp_f32 v74, v74
    v_exp_f32 v90, v90
    v_exp_f32 v75, v75
    v_exp_f32 v91, v91
    v_exp_f32 v76, v76
    v_exp_f32 v92, v92
    v_exp_f32 v77, v77
    v_exp_f32 v93, v93
    v_exp_f32 v78, v78
    v_exp_f32 v94, v94
    v_exp_f32 v79, v79
    v_exp_f32 v95, v95
    v_pk_add_f32 v[12:13], v[64:65], v[66:67]
    v_pk_add_f32 v[224:225], v[80:81], v[82:83]
    v_pk_add_f32 v[14:15], v[68:69], v[70:71]
    v_pk_add_f32 v[226:227], v[84:85], v[86:87]
    v_pk_add_f32 v[12:13], v[12:13], v[72:73]
    v_pk_add_f32 v[224:225], v[224:225], v[88:89]
    v_pk_add_f32 v[14:15], v[14:15], v[74:75]
    v_pk_add_f32 v[226:227], v[226:227], v[90:91]
    v_pk_add_f32 v[12:13], v[12:13], v[76:77]
    v_pk_add_f32 v[224:225], v[224:225], v[92:93]
    v_pk_add_f32 v[14:15], v[14:15], v[78:79]
    v_pk_add_f32 v[226:227], v[226:227], v[94:95]
    v_pk_add_f32 v[12:13], v[12:13], v[14:15]
    v_pk_add_f32 v[224:225], v[224:225], v[226:227]
    v_add_f32 v12, v12, v13
    v_add_f32 v224, v224, v225
    v_rcp_f32 v12, v12
    v_rcp_f32 v224, v224
    v_pk_mul_f32 v[64:65], v[64:65], v[12:13] op_sel_hi:[1,0]
    v_pk_mul_f32 v[80:81], v[80:81], v[224:225] op_sel_hi:[1,0]
    v_pk_mul_f32 v[66:67], v[66:67], v[12:13] op_sel_hi:[1,0]
    v_pk_mul_f32 v[82:83], v[82:83], v[224:225] op_sel_hi:[1,0]
    v_pk_mul_f32 v[68:69], v[68:69], v[12:13] op_sel_hi:[1,0]
    v_pk_mul_f32 v[84:85], v[84:85], v[224:225] op_sel_hi:[1,0]
    v_pk_mul_f32 v[70:71], v[70:71], v[12:13] op_sel_hi:[1,0]
    v_pk_mul_f32 v[86:87], v[86:87], v[224:225] op_sel_hi:[1,0]
    v_pk_mul_f32 v[72:73], v[72:73], v[12:13] op_sel_hi:[1,0]
    v_pk_mul_f32 v[88:89], v[88:89], v[224:225] op_sel_hi:[1,0]
    v_pk_mul_f32 v[74:75], v[74:75], v[12:13] op_sel_hi:[1,0]
    v_pk_mul_f32 v[90:91], v[90:91], v[224:225] op_sel_hi:[1,0]
    v_pk_mul_f32 v[76:77], v[76:77], v[12:13] op_sel_hi:[1,0]
    v_pk_mul_f32 v[92:93], v[92:93], v[224:225] op_sel_hi:[1,0]
    v_pk_mul_f32 v[78:79], v[78:79], v[12:13] op_sel_hi:[1,0]
    v_pk_mul_f32 v[94:95], v[94:95], v[224:225] op_sel_hi:[1,0]
    v_cvt_pk_bf16_f32 v112, v64, v65
    v_cvt_pk_bf16_f32 v120, v80, v81
    v_cvt_pk_bf16_f32 v113, v66, v67
    v_cvt_pk_bf16_f32 v121, v82, v83
    v_cvt_pk_bf16_f32 v114, v68, v69
    v_cvt_pk_bf16_f32 v122, v84, v85
    v_cvt_pk_bf16_f32 v115, v70, v71
    v_cvt_pk_bf16_f32 v123, v86, v87
    v_cvt_pk_bf16_f32 v116, v72, v73
    v_cvt_pk_bf16_f32 v124, v88, v89
    v_cvt_pk_bf16_f32 v117, v74, v75
    v_cvt_pk_bf16_f32 v125, v90, v91
    v_cvt_pk_bf16_f32 v118, v76, v77
    v_cvt_pk_bf16_f32 v126, v92, v93
    v_cvt_pk_bf16_f32 v119, v78, v79
    v_cvt_pk_bf16_f32 v127, v94, v95
    s_setprio 0
    s_mov_b32 s14, 0
    s_nop 0
CKV_P:
    ds_read_b128 v[220:223], v229
    ds_read_b128 v[128:131], v228 offset:0
    ds_read_b128 v[132:135], v228 offset:544
    ds_read_b128 v[136:139], v228 offset:1088
    ds_read_b128 v[140:143], v228 offset:1632
    ds_read_b128 v[144:147], v228 offset:2176
    ds_read_b128 v[148:151], v228 offset:2720
    ds_read_b128 v[152:155], v228 offset:3264
    ds_read_b128 v[156:159], v228 offset:3808
    s_add_u32 s14, s14, 1
    s_waitcnt lgkmcnt(0)
    v_min3_u32 v220, v220, v221, v222
    v_min_u32 v220, v220, v223
    s_nop 0
    v_readfirstlane_b32 s15, v220
    s_cmp_gt_u32 s14, 0x80000
    s_nop 0
    s_cselect_b32 s15, 1, s15
    s_cmp_lt_u32 s15, 1
    s_nop 0
    s_cbranch_scc1 CKV_P
    s_setprio 1
    v_mfma_f32_32x32x16_bf16 v[32:47], v[128:131], v[96:99], 0
    v_mfma_f32_32x32x16_bf16 v[32:47], v[132:135], v[100:103], v[32:47]
    v_mfma_f32_32x32x16_bf16 v[48:63], v[136:139], v[104:107], 0
    v_mfma_f32_32x32x16_bf16 v[48:63], v[140:143], v[108:111], v[48:63]
    s_nop 9
    v_add_f32 v40, 0x358637bd, v40
    v_rcp_f32 v40, v40
    s_nop 0
    v_mul_f32 v32, v32, v40
    v_mul_f32 v33, v33, v40
    v_mul_f32 v34, v34, v40
    v_mul_f32 v35, v35, v40
    v_mul_f32 v36, v36, v40
    v_mul_f32 v37, v37, v40
    v_mul_f32 v38, v38, v40
    v_mul_f32 v39, v39, v40
    v_cvt_pk_bf16_f32 v32, v32, v33
    v_cvt_pk_bf16_f32 v33, v34, v35
    v_cvt_pk_bf16_f32 v34, v36, v37
    v_cvt_pk_bf16_f32 v35, v38, v39
    buffer_store_dwordx4 v[32:35], v254, s[56:59], s82 offen offset:0 sc1
    v_mfma_f32_32x32x16_bf16 v[64:79], v[144:147], v[112:115], 0
    v_mfma_f32_32x32x16_bf16 v[64:79], v[148:151], v[116:119], v[64:79]
    v_add_f32 v56, 0x358637bd, v56
    v_rcp_f32 v56, v56
    s_nop 0
    v_mul_f32 v48, v48, v56
    v_mul_f32 v49, v49, v56
    v_mul_f32 v50, v50, v56
    v_mul_f32 v51, v51, v56
    v_mul_f32 v52, v52, v56
    v_mul_f32 v53, v53, v56
    v_mul_f32 v54, v54, v56
    v_mul_f32 v55, v55, v56
    v_cvt_pk_bf16_f32 v48, v48, v49
    v_cvt_pk_bf16_f32 v49, v50, v51
    v_cvt_pk_bf16_f32 v50, v52, v53
    v_cvt_pk_bf16_f32 v51, v54, v55
    buffer_store_dwordx4 v[48:51], v254, s[56:59], s82 offen offset:2048 sc1
    v_mfma_f32_32x32x16_bf16 v[80:95], v[152:155], v[120:123], 0
    v_mfma_f32_32x32x16_bf16 v[80:95], v[156:159], v[124:127], v[80:95]
    v_add_f32 v72, 0x358637bd, v72
    v_rcp_f32 v72, v72
    s_nop 0
    v_mul_f32 v64, v64, v72
    v_mul_f32 v65, v65, v72
    v_mul_f32 v66, v66, v72
    v_mul_f32 v67, v67, v72
    v_mul_f32 v68, v68, v72
    v_mul_f32 v69, v69, v72
    v_mul_f32 v70, v70, v72
    v_mul_f32 v71, v71, v72
    v_cvt_pk_bf16_f32 v64, v64, v65
    v_cvt_pk_bf16_f32 v65, v66, v67
    v_cvt_pk_bf16_f32 v66, v68, v69
    v_cvt_pk_bf16_f32 v67, v70, v71
    buffer_store_dwordx4 v[64:67], v254, s[56:59], s78 offen offset:0 sc1
    v_add_f32 v88, 0x358637bd, v88
    v_rcp_f32 v88, v88
    s_nop 0
    v_mul_f32 v80, v80, v88
    v_mul_f32 v81, v81, v88
    v_mul_f32 v82, v82, v88
    v_mul_f32 v83, v83, v88
    v_mul_f32 v84, v84, v88
    v_mul_f32 v85, v85, v88
    v_mul_f32 v86, v86, v88
    v_mul_f32 v87, v87, v88
    v_cvt_pk_bf16_f32 v80, v80, v81
    v_cvt_pk_bf16_f32 v81, v82, v83
    v_cvt_pk_bf16_f32 v82, v84, v85
    v_cvt_pk_bf16_f32 v83, v86, v87
    buffer_store_dwordx4 v[80:83], v254, s[56:59], s78 offen offset:2048 sc1
    s_waitcnt vmcnt(0)
    buffer_store_dword v252, v249, s[56:59], s83 offen offset:512 sc1
    s_branch C_P2
CX_START:
    v_mov_b32 v8, -1
    v_mov_b32 v9, -1
    v_mov_b32 v10, -1
    v_mov_b32 v11, -1
    s_mul_i32 s15, s85, 245760
    s_lshl_b32 s14, s10, 1
    s_add_u32 s14, s14, s86
    s_lshl_b32 s14, s14, 1
    s_add_u32 s14, s14, s87
    s_mul_i32 s14, s14, 18432
    s_add_u32 s48, s14, 0x800000
    s_add_u32 s49, s48, 9216
    buffer_store_dwordx4 v[8:11], v241, s[56:59], s48 offen offset:0 sc1
    buffer_store_dwordx4 v[8:11], v241, s[56:59], s49 offen offset:0 sc1
    s_barrier
    ds_read_b64_tr_b16 v[192:193], v244 offset:0
    ds_read_b64_tr_b16 v[194:195], v244 offset:512
    ds_read_b128 v[0:3], v228 offset:0
    ds_read_b128 v[216:219], v232 offset:0
    ds_read_b64_tr_b16 v[196:197], v244 offset:8192
    ds_read_b64_tr_b16 v[198:199], v244 offset:8704
    ds_read_b64_tr_b16 v[200:201], v244 offset:2048
    ds_read_b64_tr_b16 v[202:203], v244 offset:2560
    ds_read_b128 v[4:7], v229 offset:0
    ds_read_b128 v[220:223], v233 offset:0
    ds_read_b64_tr_b16 v[204:205], v244 offset:10240
    ds_read_b64_tr_b16 v[206:207], v244 offset:10752
    s_waitcnt lgkmcnt(6)
    v_mfma_f32_32x32x16_bf16 v[128:143], v[192:195], v[0:3], 0
    ds_read_b64_tr_b16 v[208:209], v244 offset:4096
    ds_read_b64_tr_b16 v[210:211], v244 offset:4608
    v_mfma_f32_32x32x16_bf16 v[144:159], v[192:195], v[216:219], 0
    ds_read_b128 v[8:11], v230 offset:0
    ds_read_b128 v[224:227], v234 offset:0
    v_mfma_f32_32x32x16_bf16 v[160:175], v[0:3], v[196:199], 0
    ds_read_b64_tr_b16 v[212:213], v244 offset:12288
    ds_read_b64_tr_b16 v[214:215], v244 offset:12800
    v_mfma_f32_32x32x16_bf16 v[176:191], v[216:219], v[196:199], 0
    s_waitcnt lgkmcnt(6)
    v_mfma_f32_32x32x16_bf16 v[128:143], v[200:203], v[4:7], v[128:143]
    ds_read_b64_tr_b16 v[192:193], v244 offset:6144
    ds_read_b64_tr_b16 v[194:195], v244 offset:6656
    v_mfma_f32_32x32x16_bf16 v[144:159], v[200:203], v[220:223], v[144:159]
    ds_read_b128 v[12:15], v231 offset:0
    ds_read_b128 v[216:219], v235 offset:0
    v_mfma_f32_32x32x16_bf16 v[160:175], v[4:7], v[204:207], v[160:175]
    ds_read_b64_tr_b16 v[196:197], v244 offset:14336
    ds_read_b64_tr_b16 v[198:199], v244 offset:14848
    v_mfma_f32_32x32x16_bf16 v[176:191], v[220:223], v[204:207], v[176:191]
    s_waitcnt lgkmcnt(6)
    v_mfma_f32_32x32x16_bf16 v[128:143], v[208:211], v[8:11], v[128:143]
    s_waitcnt lgkmcnt(0)
    s_barrier
    ds_read_b64_tr_b16 v[200:201], v244 offset:16384
    ds_read_b64_tr_b16 v[202:203], v244 offset:16896
    v_mfma_f32_32x32x16_bf16 v[144:159], v[208:211], v[224:227], v[144:159]
    ds_read_b128 v[16:19], v228 offset:16384
    ds_read_b128 v[220:223], v232 offset:16384
    v_mfma_f32_32x32x16_bf16 v[160:175], v[8:11], v[212:215], v[160:175]
    ds_read_b64_tr_b16 v[204:205], v244 offset:24576
    ds_read_b64_tr_b16 v[206:207], v244 offset:25088
    v_mfma_f32_32x32x16_bf16 v[176:191], v[224:227], v[212:215], v[176:191]
    v_mfma_f32_32x32x16_bf16 v[128:143], v[192:195], v[12:15], v[128:143]
    ds_read_b64_tr_b16 v[208:209], v244 offset:18432
    ds_read_b64_tr_b16 v[210:211], v244 offset:18944
    v_mfma_f32_32x32x16_bf16 v[144:159], v[192:195], v[216:219], v[144:159]
    ds_read_b128 v[20:23], v229 offset:16384
    ds_read_b128 v[224:227], v233 offset:16384
    v_mfma_f32_32x32x16_bf16 v[160:175], v[12:15], v[196:199], v[160:175]
    ds_read_b64_tr_b16 v[212:213], v244 offset:26624
    ds_read_b64_tr_b16 v[214:215], v244 offset:27136
    v_mfma_f32_32x32x16_bf16 v[176:191], v[216:219], v[196:199], v[176:191]
    s_waitcnt lgkmcnt(6)
    v_mfma_f32_32x32x16_bf16 v[128:143], v[200:203], v[16:19], v[128:143]
    ds_read_b64_tr_b16 v[192:193], v244 offset:20480
    ds_read_b64_tr_b16 v[194:195], v244 offset:20992
    v_mfma_f32_32x32x16_bf16 v[144:159], v[200:203], v[220:223], v[144:159]
    ds_read_b128 v[24:27], v230 offset:16384
    ds_read_b128 v[216:219], v234 offset:16384
    v_mfma_f32_32x32x16_bf16 v[160:175], v[16:19], v[204:207], v[160:175]
    ds_read_b64_tr_b16 v[196:197], v244 offset:28672
    ds_read_b64_tr_b16 v[198:199], v244 offset:29184
    v_mfma_f32_32x32x16_bf16 v[176:191], v[220:223], v[204:207], v[176:191]
    s_waitcnt lgkmcnt(6)
    v_mfma_f32_32x32x16_bf16 v[128:143], v[208:211], v[20:23], v[128:143]
    ds_read_b64_tr_b16 v[200:201], v244 offset:22528
    ds_read_b64_tr_b16 v[202:203], v244 offset:23040
    v_mfma_f32_32x32x16_bf16 v[144:159], v[208:211], v[224:227], v[144:159]
    ds_read_b128 v[28:31], v231 offset:16384
    ds_read_b128 v[220:223], v235 offset:16384
    v_mfma_f32_32x32x16_bf16 v[160:175], v[20:23], v[212:215], v[160:175]
    ds_read_b64_tr_b16 v[204:205], v244 offset:30720
    ds_read_b64_tr_b16 v[206:207], v244 offset:31232
    v_mfma_f32_32x32x16_bf16 v[176:191], v[224:227], v[212:215], v[176:191]
    s_waitcnt lgkmcnt(6)
    v_mfma_f32_32x32x16_bf16 v[128:143], v[192:195], v[24:27], v[128:143]
    s_waitcnt lgkmcnt(0)
    s_barrier
    ds_read_b64_tr_b16 v[208:209], v244 offset:32768
    ds_read_b64_tr_b16 v[210:211], v244 offset:33280
    v_mfma_f32_32x32x16_bf16 v[144:159], v[192:195], v[216:219], v[144:159]
    ds_read_b128 v[32:35], v228 offset:32768
    ds_read_b128 v[224:227], v232 offset:32768
    v_mfma_f32_32x32x16_bf16 v[160:175], v[24:27], v[196:199], v[160:175]
    ds_read_b64_tr_b16 v[212:213], v244 offset:40960
    ds_read_b64_tr_b16 v[214:215], v244 offset:41472
    v_mfma_f32_32x32x16_bf16 v[176:191], v[216:219], v[196:199], v[176:191]
    v_mfma_f32_32x32x16_bf16 v[128:143], v[200:203], v[28:31], v[128:143]
    ds_read_b64_tr_b16 v[192:193], v244 offset:34816
    ds_read_b64_tr_b16 v[194:195], v244 offset:35328
    v_mfma_f32_32x32x16_bf16 v[144:159], v[200:203], v[220:223], v[144:159]
    ds_read_b128 v[36:39], v229 offset:32768
    ds_read_b128 v[216:219], v233 offset:32768
    v_mfma_f32_32x32x16_bf16 v[160:175], v[28:31], v[204:207], v[160:175]
    ds_read_b64_tr_b16 v[196:197], v244 offset:43008
    ds_read_b64_tr_b16 v[198:199], v244 offset:43520
    v_mfma_f32_32x32x16_bf16 v[176:191], v[220:223], v[204:207], v[176:191]
    s_waitcnt lgkmcnt(6)
    v_mfma_f32_32x32x16_bf16 v[128:143], v[208:211], v[32:35], v[128:143]
    ds_read_b64_tr_b16 v[200:201], v244 offset:36864
    ds_read_b64_tr_b16 v[202:203], v244 offset:37376
    v_mfma_f32_32x32x16_bf16 v[144:159], v[208:211], v[224:227], v[144:159]
    ds_read_b128 v[40:43], v230 offset:32768
    ds_read_b128 v[220:223], v234 offset:32768
    v_mfma_f32_32x32x16_bf16 v[160:175], v[32:35], v[212:215], v[160:175]
    ds_read_b64_tr_b16 v[204:205], v244 offset:45056
    ds_read_b64_tr_b16 v[206:207], v244 offset:45568
    v_mfma_f32_32x32x16_bf16 v[176:191], v[224:227], v[212:215], v[176:191]
    s_waitcnt lgkmcnt(6)
    v_mfma_f32_32x32x16_bf16 v[128:143], v[192:195], v[36:39], v[128:143]
    ds_read_b64_tr_b16 v[208:209], v244 offset:38912
    ds_read_b64_tr_b16 v[210:211], v244 offset:39424
    v_mfma_f32_32x32x16_bf16 v[144:159], v[192:195], v[216:219], v[144:159]
    ds_read_b128 v[44:47], v231 offset:32768
    ds_read_b128 v[224:227], v235 offset:32768
    v_mfma_f32_32x32x16_bf16 v[160:175], v[36:39], v[196:199], v[160:175]
    ds_read_b64_tr_b16 v[212:213], v244 offset:47104
    ds_read_b64_tr_b16 v[214:215], v244 offset:47616
    v_mfma_f32_32x32x16_bf16 v[176:191], v[216:219], v[196:199], v[176:191]
    s_waitcnt lgkmcnt(6)
    v_mfma_f32_32x32x16_bf16 v[128:143], v[200:203], v[40:43], v[128:143]
    s_waitcnt lgkmcnt(0)
    s_barrier
    ds_read_b64_tr_b16 v[192:193], v244 offset:49152
    ds_read_b64_tr_b16 v[194:195], v244 offset:49664
    v_mfma_f32_32x32x16_bf16 v[144:159], v[200:203], v[220:223], v[144:159]
    ds_read_b128 v[48:51], v228 offset:49152
    ds_read_b128 v[216:219], v232 offset:49152
    v_mfma_f32_32x32x16_bf16 v[160:175], v[40:43], v[204:207], v[160:175]
    ds_read_b64_tr_b16 v[196:197], v244 offset:57344
    ds_read_b64_tr_b16 v[198:199], v244 offset:57856
    v_mfma_f32_32x32x16_bf16 v[176:191], v[220:223], v[204:207], v[176:191]
    v_mfma_f32_32x32x16_bf16 v[128:143], v[208:211], v[44:47], v[128:143]
    ds_read_b64_tr_b16 v[200:201], v244 offset:51200
    ds_read_b64_tr_b16 v[202:203], v244 offset:51712
    v_mfma_f32_32x32x16_bf16 v[144:159], v[208:211], v[224:227], v[144:159]
    ds_read_b128 v[52:55], v229 offset:49152
    ds_read_b128 v[220:223], v233 offset:49152
    v_mfma_f32_32x32x16_bf16 v[160:175], v[44:47], v[212:215], v[160:175]
    ds_read_b64_tr_b16 v[204:205], v244 offset:59392
    ds_read_b64_tr_b16 v[206:207], v244 offset:59904
    v_mfma_f32_32x32x16_bf16 v[176:191], v[224:227], v[212:215], v[176:191]
    s_waitcnt lgkmcnt(6)
    v_mfma_f32_32x32x16_bf16 v[128:143], v[192:195], v[48:51], v[128:143]
    ds_read_b64_tr_b16 v[208:209], v244 offset:53248
    ds_read_b64_tr_b16 v[210:211], v244 offset:53760
    v_mfma_f32_32x32x16_bf16 v[144:159], v[192:195], v[216:219], v[144:159]
    ds_read_b128 v[56:59], v230 offset:49152
    ds_read_b128 v[224:227], v234 offset:49152
    v_mfma_f32_32x32x16_bf16 v[160:175], v[48:51], v[196:199], v[160:175]
    ds_read_b64_tr_b16 v[212:213], v244 offset:61440
    ds_read_b64_tr_b16 v[214:215], v244 offset:61952
    v_mfma_f32_32x32x16_bf16 v[176:191], v[216:219], v[196:199], v[176:191]
    s_waitcnt lgkmcnt(6)
    v_mfma_f32_32x32x16_bf16 v[128:143], v[200:203], v[52:55], v[128:143]
    ds_read_b64_tr_b16 v[192:193], v244 offset:55296
    ds_read_b64_tr_b16 v[194:195], v244 offset:55808
    v_mfma_f32_32x32x16_bf16 v[144:159], v[200:203], v[220:223], v[144:159]
    ds_read_b128 v[60:63], v231 offset:49152
    ds_read_b128 v[216:219], v235 offset:49152
    v_mfma_f32_32x32x16_bf16 v[160:175], v[52:55], v[204:207], v[160:175]
    ds_read_b64_tr_b16 v[196:197], v244 offset:63488
    ds_read_b64_tr_b16 v[198:199], v244 offset:64000
    v_mfma_f32_32x32x16_bf16 v[176:191], v[220:223], v[204:207], v[176:191]
    s_waitcnt lgkmcnt(6)
    v_mfma_f32_32x32x16_bf16 v[128:143], v[208:211], v[56:59], v[128:143]
    s_waitcnt lgkmcnt(0)
    s_barrier
    ds_read_b64_tr_b16 v[200:201], v244 offset:0
    ds_read_b64_tr_b16 v[202:203], v244 offset:512
    v_mfma_f32_32x32x16_bf16 v[144:159], v[208:211], v[224:227], v[144:159]
    ds_read_b128 v[64:67], v228 offset:0
    ds_read_b128 v[220:223], v232 offset:0
    v_mfma_f32_32x32x16_bf16 v[160:175], v[56:59], v[212:215], v[160:175]
    ds_read_b64_tr_b16 v[204:205], v244 offset:8192
    ds_read_b64_tr_b16 v[206:207], v244 offset:8704
    v_mfma_f32_32x32x16_bf16 v[176:191], v[224:227], v[212:215], v[176:191]
    v_mfma_f32_32x32x16_bf16 v[128:143], v[192:195], v[60:63], v[128:143]
    ds_read_b64_tr_b16 v[208:209], v244 offset:2048
    ds_read_b64_tr_b16 v[210:211], v244 offset:2560
    v_mfma_f32_32x32x16_bf16 v[144:159], v[192:195], v[216:219], v[144:159]
    ds_read_b128 v[68:71], v229 offset:0
    ds_read_b128 v[224:227], v233 offset:0
    v_mfma_f32_32x32x16_bf16 v[160:175], v[60:63], v[196:199], v[160:175]
    ds_read_b64_tr_b16 v[212:213], v244 offset:10240
    ds_read_b64_tr_b16 v[214:215], v244 offset:10752
    v_mfma_f32_32x32x16_bf16 v[176:191], v[216:219], v[196:199], v[176:191]
    s_waitcnt lgkmcnt(6)
    v_mfma_f32_32x32x16_bf16 v[128:143], v[200:203], v[64:67], v[128:143]
    ds_read_b64_tr_b16 v[192:193], v244 offset:4096
    ds_read_b64_tr_b16 v[194:195], v244 offset:4608
    v_mfma_f32_32x32x16_bf16 v[144:159], v[200:203], v[220:223], v[144:159]
    ds_read_b128 v[72:75], v230 offset:0
    ds_read_b128 v[216:219], v234 offset:0
    v_mfma_f32_32x32x16_bf16 v[160:175], v[64:67], v[204:207], v[160:175]
    ds_read_b64_tr_b16 v[196:197], v244 offset:12288
    ds_read_b64_tr_b16 v[198:199], v244 offset:12800
    v_mfma_f32_32x32x16_bf16 v[176:191], v[220:223], v[204:207], v[176:191]
    s_waitcnt lgkmcnt(6)
    v_mfma_f32_32x32x16_bf16 v[128:143], v[208:211], v[68:71], v[128:143]
    ds_read_b64_tr_b16 v[200:201], v244 offset:6144
    ds_read_b64_tr_b16 v[202:203], v244 offset:6656
    v_mfma_f32_32x32x16_bf16 v[144:159], v[208:211], v[224:227], v[144:159]
    ds_read_b128 v[76:79], v231 offset:0
    ds_read_b128 v[220:223], v235 offset:0
    v_mfma_f32_32x32x16_bf16 v[160:175], v[68:71], v[212:215], v[160:175]
    ds_read_b64_tr_b16 v[204:205], v244 offset:14336
    ds_read_b64_tr_b16 v[206:207], v244 offset:14848
    v_mfma_f32_32x32x16_bf16 v[176:191], v[224:227], v[212:215], v[176:191]
    s_waitcnt lgkmcnt(6)
    v_mfma_f32_32x32x16_bf16 v[128:143], v[192:195], v[72:75], v[128:143]
    s_waitcnt lgkmcnt(0)
    s_barrier
    ds_read_b64_tr_b16 v[208:209], v244 offset:16384
    ds_read_b64_tr_b16 v[210:211], v244 offset:16896
    v_mfma_f32_32x32x16_bf16 v[144:159], v[192:195], v[216:219], v[144:159]
    ds_read_b128 v[80:83], v228 offset:16384
    ds_read_b128 v[224:227], v232 offset:16384
    v_mfma_f32_32x32x16_bf16 v[160:175], v[72:75], v[196:199], v[160:175]
    ds_read_b64_tr_b16 v[212:213], v244 offset:24576
    ds_read_b64_tr_b16 v[214:215], v244 offset:25088
    v_mfma_f32_32x32x16_bf16 v[176:191], v[216:219], v[196:199], v[176:191]
    s_add_u32 s14, s81, 0
    buffer_load_dword v251, v250, s[64:67], s14 offen
    v_mfma_f32_32x32x16_bf16 v[128:143], v[200:203], v[76:79], v[128:143]
    ds_read_b64_tr_b16 v[192:193], v244 offset:18432
    ds_read_b64_tr_b16 v[194:195], v244 offset:18944
    v_mfma_f32_32x32x16_bf16 v[144:159], v[200:203], v[220:223], v[144:159]
    ds_read_b128 v[84:87], v229 offset:16384
    ds_read_b128 v[216:219], v233 offset:16384
    v_mfma_f32_32x32x16_bf16 v[160:175], v[76:79], v[204:207], v[160:175]
    ds_read_b64_tr_b16 v[196:197], v244 offset:26624
    ds_read_b64_tr_b16 v[198:199], v244 offset:27136
    v_mfma_f32_32x32x16_bf16 v[176:191], v[220:223], v[204:207], v[176:191]
    s_waitcnt lgkmcnt(6)
    v_mfma_f32_32x32x16_bf16 v[128:143], v[208:211], v[80:83], v[128:143]
    ds_read_b64_tr_b16 v[200:201], v244 offset:20480
    ds_read_b64_tr_b16 v[202:203], v244 offset:20992
    v_mfma_f32_32x32x16_bf16 v[144:159], v[208:211], v[224:227], v[144:159]
    ds_read_b128 v[88:91], v230 offset:16384
    ds_read_b128 v[220:223], v234 offset:16384
    v_mfma_f32_32x32x16_bf16 v[160:175], v[80:83], v[212:215], v[160:175]
    ds_read_b64_tr_b16 v[204:205], v244 offset:28672
    ds_read_b64_tr_b16 v[206:207], v244 offset:29184
    v_mfma_f32_32x32x16_bf16 v[176:191], v[224:227], v[212:215], v[176:191]
    s_add_u32 s14, s81, 131072
    buffer_load_dword v251, v250, s[64:67], s14 offen
    s_waitcnt lgkmcnt(6)
    v_mfma_f32_32x32x16_bf16 v[128:143], v[192:195], v[84:87], v[128:143]
    ds_read_b64_tr_b16 v[208:209], v244 offset:22528
    ds_read_b64_tr_b16 v[210:211], v244 offset:23040
    v_mfma_f32_32x32x16_bf16 v[144:159], v[192:195], v[216:219], v[144:159]
    ds_read_b128 v[92:95], v231 offset:16384
    ds_read_b128 v[224:227], v235 offset:16384
    v_mfma_f32_32x32x16_bf16 v[160:175], v[84:87], v[196:199], v[160:175]
    ds_read_b64_tr_b16 v[212:213], v244 offset:30720
    ds_read_b64_tr_b16 v[214:215], v244 offset:31232
    v_mfma_f32_32x32x16_bf16 v[176:191], v[216:219], v[196:199], v[176:191]
    s_waitcnt lgkmcnt(6)
    v_mfma_f32_32x32x16_bf16 v[128:143], v[200:203], v[88:91], v[128:143]
    s_waitcnt lgkmcnt(0)
    s_barrier
    ds_read_b64_tr_b16 v[192:193], v244 offset:32768
    ds_read_b64_tr_b16 v[194:195], v244 offset:33280
    v_mfma_f32_32x32x16_bf16 v[144:159], v[200:203], v[220:223], v[144:159]
    ds_read_b128 v[96:99], v228 offset:32768
    ds_read_b128 v[216:219], v232 offset:32768
    v_mfma_f32_32x32x16_bf16 v[160:175], v[88:91], v[204:207], v[160:175]
    ds_read_b64_tr_b16 v[196:197], v244 offset:40960
    ds_read_b64_tr_b16 v[198:199], v244 offset:41472
    v_mfma_f32_32x32x16_bf16 v[176:191], v[220:223], v[204:207], v[176:191]
    s_add_u32 s14, s83, 0
    buffer_load_dword v251, v250, s[68:71], s14 offen
    v_mfma_f32_32x32x16_bf16 v[128:143], v[208:211], v[92:95], v[128:143]
    ds_read_b64_tr_b16 v[200:201], v244 offset:34816
    ds_read_b64_tr_b16 v[202:203], v244 offset:35328
    v_mfma_f32_32x32x16_bf16 v[144:159], v[208:211], v[224:227], v[144:159]
    ds_read_b128 v[100:103], v229 offset:32768
    ds_read_b128 v[220:223], v233 offset:32768
    v_mfma_f32_32x32x16_bf16 v[160:175], v[92:95], v[212:215], v[160:175]
    ds_read_b64_tr_b16 v[204:205], v244 offset:43008
    ds_read_b64_tr_b16 v[206:207], v244 offset:43520
    v_mfma_f32_32x32x16_bf16 v[176:191], v[224:227], v[212:215], v[176:191]
    s_waitcnt lgkmcnt(6)
    v_mfma_f32_32x32x16_bf16 v[128:143], v[192:195], v[96:99], v[128:143]
    ds_read_b64_tr_b16 v[208:209], v244 offset:36864
    ds_read_b64_tr_b16 v[210:211], v244 offset:37376
    v_mfma_f32_32x32x16_bf16 v[144:159], v[192:195], v[216:219], v[144:159]
    ds_read_b128 v[104:107], v230 offset:32768
    ds_read_b128 v[224:227], v234 offset:32768
    v_mfma_f32_32x32x16_bf16 v[160:175], v[96:99], v[196:199], v[160:175]
    ds_read_b64_tr_b16 v[212:213], v244 offset:45056
    ds_read_b64_tr_b16 v[214:215], v244 offset:45568
    v_mfma_f32_32x32x16_bf16 v[176:191], v[216:219], v[196:199], v[176:191]
    s_add_u32 s14, s82, 1048576
    buffer_load_dword v251, v250, s[64:67], s14 offen
    s_waitcnt lgkmcnt(6)
    v_mfma_f32_32x32x16_bf16 v[128:143], v[200:203], v[100:103], v[128:143]
    ds_read_b64_tr_b16 v[192:193], v244 offset:38912
    ds_read_b64_tr_b16 v[194:195], v244 offset:39424
    v_mfma_f32_32x32x16_bf16 v[144:159], v[200:203], v[220:223], v[144:159]
    ds_read_b128 v[108:111], v231 offset:32768
    ds_read_b128 v[216:219], v235 offset:32768
    v_mfma_f32_32x32x16_bf16 v[160:175], v[100:103], v[204:207], v[160:175]
    ds_read_b64_tr_b16 v[196:197], v244 offset:47104
    ds_read_b64_tr_b16 v[198:199], v244 offset:47616
    v_mfma_f32_32x32x16_bf16 v[176:191], v[220:223], v[204:207], v[176:191]
    s_waitcnt lgkmcnt(6)
    v_mfma_f32_32x32x16_bf16 v[128:143], v[208:211], v[104:107], v[128:143]
    s_waitcnt lgkmcnt(0)
    s_barrier
    ds_read_b64_tr_b16 v[200:201], v244 offset:49152
    ds_read_b64_tr_b16 v[202:203], v244 offset:49664
    v_mfma_f32_32x32x16_bf16 v[144:159], v[208:211], v[224:227], v[144:159]
    ds_read_b128 v[112:115], v228 offset:49152
    ds_read_b128 v[220:223], v232 offset:49152
    v_mfma_f32_32x32x16_bf16 v[160:175], v[104:107], v[212:215], v[160:175]
    ds_read_b64_tr_b16 v[204:205], v244 offset:57344
    ds_read_b64_tr_b16 v[206:207], v244 offset:57856
    v_mfma_f32_32x32x16_bf16 v[176:191], v[224:227], v[212:215], v[176:191]
    v_mfma_f32_32x32x16_bf16 v[128:143], v[192:195], v[108:111], v[128:143]
    ds_read_b64_tr_b16 v[208:209], v244 offset:51200
    ds_read_b64_tr_b16 v[210:211], v244 offset:51712
    v_mfma_f32_32x32x16_bf16 v[144:159], v[192:195], v[216:219], v[144:159]
    ds_read_b128 v[116:119], v229 offset:49152
    ds_read_b128 v[224:227], v233 offset:49152
    v_mfma_f32_32x32x16_bf16 v[160:175], v[108:111], v[196:199], v[160:175]
    ds_read_b64_tr_b16 v[212:213], v244 offset:59392
    ds_read_b64_tr_b16 v[214:215], v244 offset:59904
    v_mfma_f32_32x32x16_bf16 v[176:191], v[216:219], v[196:199], v[176:191]
    s_waitcnt lgkmcnt(6)
    v_mfma_f32_32x32x16_bf16 v[128:143], v[200:203], v[112:115], v[128:143]
    ds_read_b64_tr_b16 v[192:193], v244 offset:53248
    ds_read_b64_tr_b16 v[194:195], v244 offset:53760
    v_mfma_f32_32x32x16_bf16 v[144:159], v[200:203], v[220:223], v[144:159]
    ds_read_b128 v[120:123], v230 offset:49152
    ds_read_b128 v[216:219], v234 offset:49152
    v_mfma_f32_32x32x16_bf16 v[160:175], v[112:115], v[204:207], v[160:175]
    ds_read_b64_tr_b16 v[196:197], v244 offset:61440
    ds_read_b64_tr_b16 v[198:199], v244 offset:61952
    v_mfma_f32_32x32x16_bf16 v[176:191], v[220:223], v[204:207], v[176:191]
    s_waitcnt lgkmcnt(6)
    v_mfma_f32_32x32x16_bf16 v[128:143], v[208:211], v[116:119], v[128:143]
    ds_read_b64_tr_b16 v[200:201], v244 offset:55296
    ds_read_b64_tr_b16 v[202:203], v244 offset:55808
    v_mfma_f32_32x32x16_bf16 v[144:159], v[208:211], v[224:227], v[144:159]
    ds_read_b128 v[124:127], v231 offset:49152
    ds_read_b128 v[220:223], v235 offset:49152
    v_mfma_f32_32x32x16_bf16 v[160:175], v[116:119], v[212:215], v[160:175]
    ds_read_b64_tr_b16 v[204:205], v244 offset:63488
    ds_read_b64_tr_b16 v[206:207], v244 offset:64000
    v_mfma_f32_32x32x16_bf16 v[176:191], v[224:227], v[212:215], v[176:191]
    v_add_u32 v208, s80, v245
    v_xor_b32 v228, 256, v246
    v_xor_b32 v234, 128, v247
    v_mov_b32 v252, 134912
    s_waitcnt lgkmcnt(6)
    v_mfma_f32_32x32x16_bf16 v[128:143], v[192:195], v[120:123], v[128:143]
    s_waitcnt lgkmcnt(0)
    s_barrier
    ds_read_b32 v212, v208 offset:256
    ds_read_b32 v208, v208
    ds_read_b32 v224, v246
    v_mfma_f32_32x32x16_bf16 v[144:159], v[192:195], v[216:219], v[144:159]
    ds_read_b32 v228, v228
    ds_read_b32 v232, v247
    ds_read_b32 v234, v234
    v_mfma_f32_32x32x16_bf16 v[160:175], v[120:123], v[196:199], v[160:175]
    ds_read_b32 v252, v252
    v_mfma_f32_32x32x16_bf16 v[176:191], v[216:219], v[196:199], v[176:191]
    v_mfma_f32_32x32x16_bf16 v[128:143], v[200:203], v[124:127], v[128:143]
    ds_read_b64_tr_b16 v[192:193], v248 offset:0
    ds_read_b64_tr_b16 v[194:195], v248 offset:256
    ds_read_b64_tr_b16 v[196:197], v248 offset:512
    ds_read_b64_tr_b16 v[198:199], v248 offset:768
    v_mov_b32 v209, 0
    v_mov_b32 v210, 0
    v_mfma_f32_32x32x16_bf16 v[144:159], v[200:203], v[220:223], v[144:159]
    v_mov_b32 v211, 0
    v_mov_b32 v213, 0
    v_mov_b32 v214, 0
    v_mov_b32 v215, 0
    v_mov_b32 v225, 0
    v_mov_b32 v226, 0
    v_mfma_f32_32x32x16_bf16 v[160:175], v[124:127], v[204:207], v[160:175]
    v_mov_b32 v227, 0
    v_mov_b32 v229, 0
    v_mov_b32 v230, 0
    v_mov_b32 v231, 0
    v_mfma_f32_32x32x16_bf16 v[176:191], v[220:223], v[204:207], v[176:191]
    s_setprio 1
    s_waitcnt lgkmcnt(4)
    v_mfma_f32_32x32x16_bf16 v[128:143], v[208:211], v[224:227], v[128:143]
    v_mfma_f32_32x32x16_bf16 v[144:159], v[208:211], v[228:231], v[144:159]
    v_mfma_f32_32x32x16_bf16 v[160:175], v[224:227], v[212:215], v[160:175]
    v_mfma_f32_32x32x16_bf16 v[176:191], v[228:231], v[212:215], v[176:191]
    v_readfirstlane_b32 s3, v252
    s_lshl_b32 s83, s85, 10
    s_add_u32 s83, s83, 0xc90000
    s_mul_i32 s82, s85, 245760
    s_lshl_b32 s14, s86, 10
    s_add_u32 s82, s82, s14
    v_lshlrev_b32 v220, 2, v240
    v_add_u32 v217, v239, v240
    v_add_u32 v218, v217, v240
    v_add_u32 v219, v218, v240
    v_xor_b32 v220, v220, v239
    v_add_u32 v221, v220, v240
    v_add_u32 v222, v221, v240
    v_add_u32 v223, v222, v240
    v_bfe_u32 v253, v255, 2, 1
    v_mul_u32_u24 v253, 0x8000, v253
    v_lshl_or_b32 v253, v253, 16, v253
    s_waitcnt lgkmcnt(0)
    v_xor_b32 v192, v253, v192
    v_xor_b32 v193, v253, v193
    v_xor_b32 v194, v253, v194
    v_xor_b32 v195, v253, v195
    v_xor_b32 v196, v253, v196
    v_xor_b32 v197, v253, v197
    v_xor_b32 v198, v253, v198
    v_xor_b32 v199, v253, v199
    v_pk_mul_f32 v[128:129], v[128:129], v[232:233] op_sel_hi:[1,0]
    v_pk_mul_f32 v[130:131], v[130:131], v[232:233] op_sel_hi:[1,0]
    v_pk_mul_f32 v[132:133], v[132:133], v[232:233] op_sel_hi:[1,0]
    v_pk_mul_f32 v[134:135], v[134:135], v[232:233] op_sel_hi:[1,0]
    v_pk_mul_f32 v[136:137], v[136:137], v[232:233] op_sel_hi:[1,0]
    v_pk_mul_f32 v[138:139], v[138:139], v[232:233] op_sel_hi:[1,0]
    v_pk_mul_f32 v[140:141], v[140:141], v[232:233] op_sel_hi:[1,0]
    v_pk_mul_f32 v[142:143], v[142:143], v[232:233] op_sel_hi:[1,0]
    v_cvt_pk_bf16_f32 v128, v128, v129
    v_cvt_pk_bf16_f32 v129, v130, v131
    v_cvt_pk_bf16_f32 v130, v132, v133
    v_cvt_pk_bf16_f32 v131, v134, v135
    v_cvt_pk_bf16_f32 v132, v136, v137
    v_cvt_pk_bf16_f32 v133, v138, v139
    v_cvt_pk_bf16_f32 v134, v140, v141
    v_cvt_pk_bf16_f32 v135, v142, v143
    v_mfma_f32_32x32x16_bf16 v[200:215], v[192:195], v[128:131], 0
    v_pk_mul_f32 v[144:145], v[144:145], v[234:235] op_sel_hi:[1,0]
    v_pk_mul_f32 v[146:147], v[146:147], v[234:235] op_sel_hi:[1,0]
    v_pk_mul_f32 v[148:149], v[148:149], v[234:235] op_sel_hi:[1,0]
    v_pk_mul_f32 v[150:151], v[150:151], v[234:235] op_sel_hi:[1,0]
    v_pk_mul_f32 v[152:153], v[152:153], v[234:235] op_sel_hi:[1,0]
    v_pk_mul_f32 v[154:155], v[154:155], v[234:235] op_sel_hi:[1,0]
    v_pk_mul_f32 v[156:157], v[156:157], v[234:235] op_sel_hi:[1,0]
    v_pk_mul_f32 v[158:159], v[158:159], v[234:235] op_sel_hi:[1,0]
    v_cvt_pk_bf16_f32 v136, v144, v145
    v_cvt_pk_bf16_f32 v137, v146, v147
    v_cvt_pk_bf16_f32 v138, v148, v149
    v_cvt_pk_bf16_f32 v139, v150, v151
    v_cvt_pk_bf16_f32 v140, v152, v153
    v_cvt_pk_bf16_f32 v141, v154, v155
    v_cvt_pk_bf16_f32 v142, v156, v157
    v_cvt_pk_bf16_f32 v143, v158, v159
    v_mfma_f32_32x32x16_bf16 v[144:159], v[196:199], v[132:135], 0
    v_cvt_pk_bf16_f32 v160, v160, v161
    v_cvt_pk_bf16_f32 v161, v162, v163
    v_cvt_pk_bf16_f32 v162, v164, v165
    v_cvt_pk_bf16_f32 v163, v166, v167
    v_cvt_pk_bf16_f32 v164, v168, v169
    v_cvt_pk_bf16_f32 v165, v170, v171
    v_cvt_pk_bf16_f32 v166, v172, v173
    v_cvt_pk_bf16_f32 v167, v174, v175
    ds_write_b128 v237, v[160:163]
    v_cvt_pk_bf16_f32 v168, v176, v177
    v_cvt_pk_bf16_f32 v169, v178, v179
    v_cvt_pk_bf16_f32 v170, v180, v181
    v_cvt_pk_bf16_f32 v171, v182, v183
    v_cvt_pk_bf16_f32 v172, v184, v185
    v_cvt_pk_bf16_f32 v173, v186, v187
    v_cvt_pk_bf16_f32 v174, v188, v189
    v_cvt_pk_bf16_f32 v175, v190, v191
    v_xor_b32 v253, 2048, v237
    v_mfma_f32_32x32x16_bf16 v[176:191], v[192:195], v[136:139], 0
    s_lshl_b32 s14, s84, 3
    s_add_u32 s14, s14, 134960
    v_mov_b32 v248, s14
    s_lshl_b32 s14, s10, 1
    s_add_u32 s14, s14, s86
    s_lshl_b32 s14, s14, 1
    s_add_u32 s14, s14, s87
    s_mul_i32 s78, s14, 18432
    s_add_u32 s78, s78, 0x800000
    s_add_u32 s80, s78, 9216
    s_lshl_b32 s79, s14, 5
    s_add_u32 s79, s79, s5
    s_lshl_b32 s79, s79, 2
    s_add_u32 s79, s79, 0x8a0000
    v_max3_f32 v224, v200, v201, v202
    v_max3_f32 v228, v144, v145, v146
    ds_write_b128 v237, v[164:167] offset:1024
    v_max3_f32 v225, v203, v204, v205
    v_max3_f32 v229, v147, v148, v149
    v_max3_f32 v226, v206, v207, v208
    v_max3_f32 v230, v150, v151, v152
    v_max3_f32 v227, v209, v210, v211
    v_max3_f32 v231, v153, v154, v155
    v_max3_f32 v224, v224, v212, v213
    v_max3_f32 v228, v228, v156, v157
    v_max3_f32 v225, v225, v214, v215
    v_max3_f32 v229, v229, v158, v159
    v_max3_f32 v224, v224, v225, v226
    v_max3_f32 v228, v228, v229, v230
    v_max_f32 v224, v224, v227
    v_max_f32 v228, v228, v231
    v_mul_f32 v224, 0xbfb8aa3b, v224
    v_mul_f32 v228, 0xbfb8aa3b, v228
    v_pk_fma_f32 v[200:201], v[200:201], s[52:53], v[224:225] op_sel_hi:[1,1,0]
    v_pk_fma_f32 v[144:145], v[144:145], s[52:53], v[228:229] op_sel_hi:[1,1,0]
    v_pk_fma_f32 v[202:203], v[202:203], s[52:53], v[224:225] op_sel_hi:[1,1,0]
    v_pk_fma_f32 v[146:147], v[146:147], s[52:53], v[228:229] op_sel_hi:[1,1,0]
    ds_write_b128 v253, v[168:171] offset:0
    v_pk_fma_f32 v[204:205], v[204:205], s[52:53], v[224:225] op_sel_hi:[1,1,0]
    v_pk_fma_f32 v[148:149], v[148:149], s[52:53], v[228:229] op_sel_hi:[1,1,0]
    v_pk_fma_f32 v[206:207], v[206:207], s[52:53], v[224:225] op_sel_hi:[1,1,0]
    v_pk_fma_f32 v[150:151], v[150:151], s[52:53], v[228:229] op_sel_hi:[1,1,0]
    v_pk_fma_f32 v[208:209], v[208:209], s[52:53], v[224:225] op_sel_hi:[1,1,0]
    v_pk_fma_f32 v[152:153], v[152:153], s[52:53], v[228:229] op_sel_hi:[1,1,0]
    v_pk_fma_f32 v[210:211], v[210:211], s[52:53], v[224:225] op_sel_hi:[1,1,0]
    v_pk_fma_f32 v[154:155], v[154:155], s[52:53], v[228:229] op_sel_hi:[1,1,0]
    v_pk_fma_f32 v[212:213], v[212:213], s[52:53], v[224:225] op_sel_hi:[1,1,0]
    v_pk_fma_f32 v[156:157], v[156:157], s[52:53], v[228:229] op_sel_hi:[1,1,0]
    v_pk_fma_f32 v[214:215], v[214:215], s[52:53], v[224:225] op_sel_hi:[1,1,0]
    v_pk_fma_f32 v[158:159], v[158:159], s[52:53], v[228:229] op_sel_hi:[1,1,0]
    v_exp_f32 v200, v200
    v_exp_f32 v144, v144
    v_exp_f32 v201, v201
    v_exp_f32 v145, v145
    v_exp_f32 v202, v202
    v_exp_f32 v146, v146
    v_exp_f32 v203, v203
    v_exp_f32 v147, v147
    ds_write_b128 v253, v[172:175] offset:1024
    v_exp_f32 v204, v204
    v_exp_f32 v148, v148
    v_exp_f32 v205, v205
    v_exp_f32 v149, v149
    v_exp_f32 v206, v206
    v_exp_f32 v150, v150
    v_exp_f32 v207, v207
    v_exp_f32 v151, v151
    v_exp_f32 v208, v208
    v_exp_f32 v152, v152
    v_exp_f32 v209, v209
    v_exp_f32 v153, v153
    v_exp_f32 v210, v210
    v_exp_f32 v154, v154
    v_exp_f32 v211, v211
    v_exp_f32 v155, v155
    v_exp_f32 v212, v212
    v_exp_f32 v156, v156
    v_exp_f32 v213, v213
    v_exp_f32 v157, v157
    v_mfma_f32_32x32x16_bf16 v[160:175], v[196:199], v[140:143], 0
    v_exp_f32 v214, v214
    v_exp_f32 v158, v158
    v_exp_f32 v215, v215
    v_exp_f32 v159, v159
    v_pk_add_f32 v[224:225], v[200:201], v[202:203]
    v_pk_add_f32 v[228:229], v[144:145], v[146:147]
    v_pk_add_f32 v[226:227], v[204:205], v[206:207]
    v_pk_add_f32 v[230:231], v[148:149], v[150:151]
    v_pk_add_f32 v[224:225], v[224:225], v[208:209]
    v_pk_add_f32 v[228:229], v[228:229], v[152:153]
    v_pk_add_f32 v[226:227], v[226:227], v[210:211]
    v_pk_add_f32 v[230:231], v[230:231], v[154:155]
    v_pk_add_f32 v[224:225], v[224:225], v[212:213]
    v_pk_add_f32 v[228:229], v[228:229], v[156:157]
    v_pk_add_f32 v[226:227], v[226:227], v[214:215]
    v_pk_add_f32 v[230:231], v[230:231], v[158:159]
    v_pk_add_f32 v[224:225], v[224:225], v[226:227]
    v_pk_add_f32 v[228:229], v[228:229], v[230:231]
    v_add_f32 v224, v224, v225
    v_add_f32 v228, v228, v229
    v_rcp_f32 v224, v224
    v_rcp_f32 v228, v228
    v_mul_f32 v224, v224, v232
    v_mul_f32 v228, v228, v232
    v_pk_mul_f32 v[200:201], v[200:201], v[224:225] op_sel_hi:[1,0]
    v_pk_mul_f32 v[144:145], v[144:145], v[228:229] op_sel_hi:[1,0]
    v_pk_mul_f32 v[202:203], v[202:203], v[224:225] op_sel_hi:[1,0]
    v_pk_mul_f32 v[146:147], v[146:147], v[228:229] op_sel_hi:[1,0]
    v_pk_mul_f32 v[204:205], v[204:205], v[224:225] op_sel_hi:[1,0]
    v_pk_mul_f32 v[148:149], v[148:149], v[228:229] op_sel_hi:[1,0]
    v_pk_mul_f32 v[206:207], v[206:207], v[224:225] op_sel_hi:[1,0]
    v_pk_mul_f32 v[150:151], v[150:151], v[228:229] op_sel_hi:[1,0]
    v_pk_mul_f32 v[208:209], v[208:209], v[224:225] op_sel_hi:[1,0]
    v_pk_mul_f32 v[152:153], v[152:153], v[228:229] op_sel_hi:[1,0]
    v_pk_mul_f32 v[210:211], v[210:211], v[224:225] op_sel_hi:[1,0]
    v_pk_mul_f32 v[154:155], v[154:155], v[228:229] op_sel_hi:[1,0]
    v_pk_mul_f32 v[212:213], v[212:213], v[224:225] op_sel_hi:[1,0]
    v_pk_mul_f32 v[156:157], v[156:157], v[228:229] op_sel_hi:[1,0]
    v_pk_mul_f32 v[214:215], v[214:215], v[224:225] op_sel_hi:[1,0]
    v_pk_mul_f32 v[158:159], v[158:159], v[228:229] op_sel_hi:[1,0]
    v_cvt_pk_bf16_f32 v200, v200, v201
    v_cvt_pk_bf16_f32 v144, v144, v145
    v_cvt_pk_bf16_f32 v201, v202, v203
    v_cvt_pk_bf16_f32 v145, v146, v147
    v_cvt_pk_bf16_f32 v202, v204, v205
    v_cvt_pk_bf16_f32 v146, v148, v149
    v_cvt_pk_bf16_f32 v203, v206, v207
    v_cvt_pk_bf16_f32 v147, v150, v151
    v_cvt_pk_bf16_f32 v204, v208, v209
    v_cvt_pk_bf16_f32 v148, v152, v153
    v_cvt_pk_bf16_f32 v205, v210, v211
    v_cvt_pk_bf16_f32 v149, v154, v155
    v_cvt_pk_bf16_f32 v206, v212, v213
    v_cvt_pk_bf16_f32 v150, v156, v157
    v_cvt_pk_bf16_f32 v207, v214, v215
    v_cvt_pk_bf16_f32 v151, v158, v159
    ds_write_b128 v236, v[200:203]
    v_max3_f32 v224, v176, v177, v178
    v_max3_f32 v228, v160, v161, v162
    v_max3_f32 v225, v179, v180, v181
    v_max3_f32 v229, v163, v164, v165
    v_max3_f32 v226, v182, v183, v184
    v_max3_f32 v230, v166, v167, v168
    v_max3_f32 v227, v185, v186, v187
    v_max3_f32 v231, v169, v170, v171
    v_max3_f32 v224, v224, v188, v189
    v_max3_f32 v228, v228, v172, v173
    v_max3_f32 v225, v225, v190, v191
    v_max3_f32 v229, v229, v174, v175
    v_max3_f32 v224, v224, v225, v226
    v_max3_f32 v228, v228, v229, v230
    v_max_f32 v224, v224, v227
    v_max_f32 v228, v228, v231
    v_mul_f32 v224, 0xbfb8aa3b, v224
    v_mul_f32 v228, 0xbfb8aa3b, v228
    v_xor_b32 v130, 64, v236
    ds_write_b128 v130, v[144:147]
    v_pk_fma_f32 v[176:177], v[176:177], s[52:53], v[224:225] op_sel_hi:[1,1,0]
    v_pk_fma_f32 v[160:161], v[160:161], s[52:53], v[228:229] op_sel_hi:[1,1,0]
    v_pk_fma_f32 v[178:179], v[178:179], s[52:53], v[224:225] op_sel_hi:[1,1,0]
    v_pk_fma_f32 v[162:163], v[162:163], s[52:53], v[228:229] op_sel_hi:[1,1,0]
    v_pk_fma_f32 v[180:181], v[180:181], s[52:53], v[224:225] op_sel_hi:[1,1,0]
    v_pk_fma_f32 v[164:165], v[164:165], s[52:53], v[228:229] op_sel_hi:[1,1,0]
    v_pk_fma_f32 v[182:183], v[182:183], s[52:53], v[224:225] op_sel_hi:[1,1,0]
    v_pk_fma_f32 v[166:167], v[166:167], s[52:53], v[228:229] op_sel_hi:[1,1,0]
    v_pk_fma_f32 v[184:185], v[184:185], s[52:53], v[224:225] op_sel_hi:[1,1,0]
    v_pk_fma_f32 v[168:169], v[168:169], s[52:53], v[228:229] op_sel_hi:[1,1,0]
    v_pk_fma_f32 v[186:187], v[186:187], s[52:53], v[224:225] op_sel_hi:[1,1,0]
    v_pk_fma_f32 v[170:171], v[170:171], s[52:53], v[228:229] op_sel_hi:[1,1,0]
    v_pk_fma_f32 v[188:189], v[188:189], s[52:53], v[224:225] op_sel_hi:[1,1,0]
    v_pk_fma_f32 v[172:173], v[172:173], s[52:53], v[228:229] op_sel_hi:[1,1,0]
    v_pk_fma_f32 v[190:191], v[190:191], s[52:53], v[224:225] op_sel_hi:[1,1,0]
    v_pk_fma_f32 v[174:175], v[174:175], s[52:53], v[228:229] op_sel_hi:[1,1,0]
    v_exp_f32 v176, v176
    v_exp_f32 v160, v160
    v_xor_b32 v129, 16, v236
    ds_write_b128 v129, v[204:207]
    v_exp_f32 v177, v177
    v_exp_f32 v161, v161
    v_exp_f32 v178, v178
    v_exp_f32 v162, v162
    v_exp_f32 v179, v179
    v_exp_f32 v163, v163
    v_exp_f32 v180, v180
    v_exp_f32 v164, v164
    v_exp_f32 v181, v181
    v_exp_f32 v165, v165
    v_exp_f32 v182, v182
    v_exp_f32 v166, v166
    v_exp_f32 v183, v183
    v_exp_f32 v167, v167
    v_exp_f32 v184, v184
    v_exp_f32 v168, v168
    v_exp_f32 v185, v185
    v_exp_f32 v169, v169
    v_xor_b32 v131, 80, v236
    ds_write_b128 v131, v[148:151]
    v_exp_f32 v186, v186
    v_exp_f32 v170, v170
    v_exp_f32 v187, v187
    v_exp_f32 v171, v171
    v_exp_f32 v188, v188
    v_exp_f32 v172, v172
    v_exp_f32 v189, v189
    v_exp_f32 v173, v173
    v_exp_f32 v190, v190
    v_exp_f32 v174, v174
    v_exp_f32 v191, v191
    v_exp_f32 v175, v175
    v_pk_add_f32 v[224:225], v[176:177], v[178:179]
    v_pk_add_f32 v[228:229], v[160:161], v[162:163]
    v_pk_add_f32 v[226:227], v[180:181], v[182:183]
    v_pk_add_f32 v[230:231], v[164:165], v[166:167]
    v_pk_add_f32 v[224:225], v[224:225], v[184:185]
    v_pk_add_f32 v[228:229], v[228:229], v[168:169]
    v_pk_add_f32 v[226:227], v[226:227], v[186:187]
    v_pk_add_f32 v[230:231], v[230:231], v[170:171]
    v_pk_add_f32 v[224:225], v[224:225], v[188:189]
    v_pk_add_f32 v[228:229], v[228:229], v[172:173]
    v_pk_add_f32 v[226:227], v[226:227], v[190:191]
    v_pk_add_f32 v[230:231], v[230:231], v[174:175]
    v_pk_add_f32 v[224:225], v[224:225], v[226:227]
    v_pk_add_f32 v[228:229], v[228:229], v[230:231]
    v_add_f32 v224, v224, v225
    v_add_f32 v228, v228, v229
    v_rcp_f32 v224, v224
    v_rcp_f32 v228, v228
    v_mul_f32 v224, v224, v234
    v_mul_f32 v228, v228, v234
    v_pk_mul_f32 v[176:177], v[176:177], v[224:225] op_sel_hi:[1,0]
    v_pk_mul_f32 v[178:179], v[178:179], v[224:225] op_sel_hi:[1,0]
    v_pk_mul_f32 v[180:181], v[180:181], v[224:225] op_sel_hi:[1,0]
    v_pk_mul_f32 v[182:183], v[182:183], v[224:225] op_sel_hi:[1,0]
    v_cvt_pk_bf16_f32 v176, v176, v177
    v_cvt_pk_bf16_f32 v177, v178, v179
    v_cvt_pk_bf16_f32 v178, v180, v181
    v_cvt_pk_bf16_f32 v179, v182, v183
    v_xor_b32 v128, 4096, v236
    ds_write_b128 v128, v[176:179]
    v_pk_mul_f32 v[184:185], v[184:185], v[224:225] op_sel_hi:[1,0]
    v_pk_mul_f32 v[186:187], v[186:187], v[224:225] op_sel_hi:[1,0]
    v_pk_mul_f32 v[188:189], v[188:189], v[224:225] op_sel_hi:[1,0]
    v_pk_mul_f32 v[190:191], v[190:191], v[224:225] op_sel_hi:[1,0]
    v_cvt_pk_bf16_f32 v180, v184, v185
    v_cvt_pk_bf16_f32 v181, v186, v187
    v_cvt_pk_bf16_f32 v182, v188, v189
    v_cvt_pk_bf16_f32 v183, v190, v191
    v_xor_b32 v129, 4112, v236
    ds_write_b128 v129, v[180:183]
    v_pk_mul_f32 v[160:161], v[160:161], v[228:229] op_sel_hi:[1,0]
    v_pk_mul_f32 v[162:163], v[162:163], v[228:229] op_sel_hi:[1,0]
    v_pk_mul_f32 v[164:165], v[164:165], v[228:229] op_sel_hi:[1,0]
    v_pk_mul_f32 v[166:167], v[166:167], v[228:229] op_sel_hi:[1,0]
    v_cvt_pk_bf16_f32 v160, v160, v161
    v_cvt_pk_bf16_f32 v161, v162, v163
    v_cvt_pk_bf16_f32 v162, v164, v165
    v_cvt_pk_bf16_f32 v163, v166, v167
    v_xor_b32 v130, 4160, v236
    ds_write_b128 v130, v[160:163]
    v_pk_mul_f32 v[168:169], v[168:169], v[228:229] op_sel_hi:[1,0]
    v_pk_mul_f32 v[170:171], v[170:171], v[228:229] op_sel_hi:[1,0]
    v_pk_mul_f32 v[172:173], v[172:173], v[228:229] op_sel_hi:[1,0]
    v_pk_mul_f32 v[174:175], v[174:175], v[228:229] op_sel_hi:[1,0]
    v_cvt_pk_bf16_f32 v164, v168, v169
    v_cvt_pk_bf16_f32 v165, v170, v171
    v_cvt_pk_bf16_f32 v166, v172, v173
    v_cvt_pk_bf16_f32 v167, v174, v175
    v_xor_b32 v131, 4176, v236
    ds_write_b128 v131, v[164:167]
    ds_write_b32 v248, v248
    s_waitcnt vmcnt(4)
    buffer_store_dword v252, v249, s[56:59], s79 offen offset:0 sc1
    ds_read_b64_tr_b16 v[128:129], v238 offset:0
    ds_read_b64_tr_b16 v[130:131], v238 offset:1024
    ds_read_b128 v[160:163], v239
    ds_read_b64_tr_b16 v[132:133], v238 offset:2048
    ds_read_b64_tr_b16 v[134:135], v238 offset:3072
    ds_read_b128 v[164:167], v217
    ds_read_b64_tr_b16 v[136:137], v238 offset:4096
    ds_read_b64_tr_b16 v[138:139], v238 offset:5120
    ds_read_b128 v[168:171], v218
    ds_read_b64_tr_b16 v[140:141], v238 offset:6144
    ds_read_b64_tr_b16 v[142:143], v238 offset:7168
    ds_read_b128 v[172:175], v219
    v_xor_b32 v248, 112, v248
    v_xor_b32 v238, 8192, v238
    s_mov_b32 s14, 0
    s_nop 1
CEX_P:
    ds_read_b32 v224, v248
    s_add_u32 s14, s14, 1
    s_waitcnt lgkmcnt(0)
    v_readfirstlane_b32 s15, v224
    s_cmp_gt_u32 s14, 0x80000
    s_nop 0
    s_cselect_b32 s15, 1, s15
    s_cmp_lt_u32 s15, 1
    s_nop 0
    s_cbranch_scc1 CEX_P
    v_mfma_f32_32x32x16_bf16 v[200:215], v[128:131], v[160:163], 0
    ds_read_b64_tr_b16 v[144:145], v238 offset:0
    ds_read_b64_tr_b16 v[146:147], v238 offset:1024
    ds_read_b128 v[176:179], v220
    v_mfma_f32_32x32x16_bf16 v[200:215], v[132:135], v[164:167], v[200:215]
    ds_read_b64_tr_b16 v[148:149], v238 offset:2048
    ds_read_b64_tr_b16 v[150:151], v238 offset:3072
    ds_read_b128 v[180:183], v221
    v_mfma_f32_32x32x16_bf16 v[200:215], v[136:139], v[168:171], v[200:215]
    ds_read_b64_tr_b16 v[152:153], v238 offset:4096
    ds_read_b64_tr_b16 v[154:155], v238 offset:5120
    ds_read_b128 v[184:187], v222
    v_mfma_f32_32x32x16_bf16 v[200:215], v[140:143], v[172:175], v[200:215]
    ds_read_b64_tr_b16 v[156:157], v238 offset:6144
    ds_read_b64_tr_b16 v[158:159], v238 offset:7168
    ds_read_b128 v[188:191], v223
    s_waitcnt lgkmcnt(9)
    v_mfma_f32_32x32x16_bf16 v[200:215], v[144:147], v[176:179], v[200:215]
    s_waitcnt lgkmcnt(6)
    v_mfma_f32_32x32x16_bf16 v[200:215], v[148:151], v[180:183], v[200:215]
    s_waitcnt lgkmcnt(3)
    v_mfma_f32_32x32x16_bf16 v[200:215], v[152:155], v[184:187], v[200:215]
    s_waitcnt lgkmcnt(0)
    v_mfma_f32_32x32x16_bf16 v[200:215], v[156:159], v[188:191], v[200:215]
    s_lshl_b32 s14, s10, 13
    s_add_u32 s82, s82, s14
    s_add_u32 s82, s82, 131072
    s_add_u32 s81, s82, 4096
    s_lshl_b32 s14, s86, 2
    s_add_u32 s83, s83, s14
    s_lshl_b32 s14, s84, 2
    s_add_u32 s14, s14, 134992
    v_mov_b32 v248, s14
    v_mul_f32 v232, 0x3fb8aa3b, v232
    s_nop 1
    v_cvt_pk_bf16_f32 v160, v200, v201
    v_cvt_pk_bf16_f32 v161, v202, v203
    v_cvt_pk_bf16_f32 v162, v204, v205
    v_cvt_pk_bf16_f32 v163, v206, v207
    buffer_store_dwordx4 v[160:163], v241, s[56:59], s78 offen sc1
    v_cvt_pk_bf16_f32 v164, v208, v209
    v_cvt_pk_bf16_f32 v165, v210, v211
    v_cvt_pk_bf16_f32 v166, v212, v213
    v_cvt_pk_bf16_f32 v167, v214, v215
    buffer_store_dwordx4 v[164:167], v241, s[56:59], s80 offen sc1
    s_cmp_ge_u32 s10, 6
    s_nop 0
    s_cbranch_scc1 CX_NOH
    s_setprio 1
    s_lshl_b32 s14, s86, 6
    v_xor_b32 v216, s14, v244
    v_add_u32 v216, 65536, v216
    v_xor_b32 v217, 64, v216
    v_mov_b32 v218, 134928
    s_mov_b32 s14, 0
    s_nop 1
CP31_P:
    ds_read_b128 v[220:223], v218
    s_add_u32 s14, s14, 1
    s_waitcnt lgkmcnt(0)
    v_min3_u32 v220, v220, v221, v222
    v_min_u32 v220, v220, v223
    s_nop 0
    v_readfirstlane_b32 s15, v220
    s_cmp_gt_u32 s14, 0x80000
    s_nop 0
    s_cselect_b32 s15, 1, s15
    s_cmp_lt_u32 s15, 1
    s_nop 0
    s_cbranch_scc1 CP31_P
    ds_read_b64_tr_b16 v[192:193], v216 offset:8192
    ds_read_b64_tr_b16 v[194:195], v216 offset:8704
    ds_read_b64_tr_b16 v[196:197], v216 offset:10240
    ds_read_b64_tr_b16 v[198:199], v216 offset:10752
    ds_read_b64_tr_b16 v[200:201], v216 offset:12288
    ds_read_b64_tr_b16 v[202:203], v216 offset:12800
    ds_read_b64_tr_b16 v[204:205], v216 offset:14336
    ds_read_b64_tr_b16 v[206:207], v216 offset:14848
    s_waitcnt lgkmcnt(4)
    v_mfma_f32_32x32x16_bf16 v[128:143], v[192:195], v[0:3], 0
    ds_read_b64_tr_b16 v[208:209], v216 offset:16384
    ds_read_b64_tr_b16 v[210:211], v216 offset:16896
    v_mfma_f32_32x32x16_bf16 v[128:143], v[196:199], v[4:7], v[128:143]
    ds_read_b64_tr_b16 v[212:213], v216 offset:18432
    ds_read_b64_tr_b16 v[214:215], v216 offset:18944
    ds_write_b32 v248, v248
    s_waitcnt lgkmcnt(5)
    v_mfma_f32_32x32x16_bf16 v[128:143], v[200:203], v[8:11], v[128:143]
    ds_read_b64_tr_b16 v[192:193], v216 offset:20480
    ds_read_b64_tr_b16 v[194:195], v216 offset:20992
    v_mfma_f32_32x32x16_bf16 v[128:143], v[204:207], v[12:15], v[128:143]
    ds_read_b64_tr_b16 v[196:197], v216 offset:22528
    ds_read_b64_tr_b16 v[198:199], v216 offset:23040
    s_waitcnt lgkmcnt(5)
    v_mfma_f32_32x32x16_bf16 v[128:143], v[208:211], v[16:19], v[128:143]
    v_add_u32 v216, -131072, v216
    ds_read_b64_tr_b16 v[200:201], v216 offset:0
    ds_read_b64_tr_b16 v[202:203], v216 offset:512
    v_mfma_f32_32x32x16_bf16 v[128:143], v[212:215], v[20:23], v[128:143]
    ds_read_b64_tr_b16 v[204:205], v216 offset:2048
    ds_read_b64_tr_b16 v[206:207], v216 offset:2560
    s_waitcnt lgkmcnt(4)
    v_mfma_f32_32x32x16_bf16 v[128:143], v[192:195], v[24:27], v[128:143]
    ds_read_b64_tr_b16 v[208:209], v216 offset:4096
    ds_read_b64_tr_b16 v[210:211], v216 offset:4608
    v_mfma_f32_32x32x16_bf16 v[128:143], v[196:199], v[28:31], v[128:143]
    ds_read_b64_tr_b16 v[212:213], v216 offset:6144
    ds_read_b64_tr_b16 v[214:215], v216 offset:6656
    s_waitcnt lgkmcnt(4)
    v_mfma_f32_32x32x16_bf16 v[128:143], v[200:203], v[32:35], v[128:143]
    ds_read_b64_tr_b16 v[192:193], v216 offset:8192
    ds_read_b64_tr_b16 v[194:195], v216 offset:8704
    v_mov_b32 v177, 0
    v_mfma_f32_32x32x16_bf16 v[128:143], v[204:207], v[36:39], v[128:143]
    ds_read_b64_tr_b16 v[196:197], v216 offset:10240
    ds_read_b64_tr_b16 v[198:199], v216 offset:10752
    v_mov_b32 v178, 0
    s_waitcnt lgkmcnt(4)
    v_mfma_f32_32x32x16_bf16 v[128:143], v[208:211], v[40:43], v[128:143]
    ds_read_b64_tr_b16 v[200:201], v216 offset:12288
    ds_read_b64_tr_b16 v[202:203], v216 offset:12800
    v_mov_b32 v179, 0
    v_mfma_f32_32x32x16_bf16 v[128:143], v[212:215], v[44:47], v[128:143]
    ds_read_b64_tr_b16 v[204:205], v216 offset:14336
    ds_read_b64_tr_b16 v[206:207], v216 offset:14848
    v_mov_b32 v181, 0
    s_waitcnt lgkmcnt(4)
    v_mfma_f32_32x32x16_bf16 v[128:143], v[192:195], v[48:51], v[128:143]
    v_add_u32 v216, 65536, v216
    ds_read_b64_tr_b16 v[208:209], v216 offset:0
    ds_read_b64_tr_b16 v[210:211], v216 offset:512
    v_mov_b32 v182, 0
    v_mfma_f32_32x32x16_bf16 v[128:143], v[196:199], v[52:55], v[128:143]
    ds_read_b64_tr_b16 v[212:213], v216 offset:2048
    ds_read_b64_tr_b16 v[214:215], v216 offset:2560
    v_mov_b32 v183, 0
    s_waitcnt lgkmcnt(4)
    v_mfma_f32_32x32x16_bf16 v[128:143], v[200:203], v[56:59], v[128:143]
    ds_read_b64_tr_b16 v[192:193], v216 offset:4096
    ds_read_b64_tr_b16 v[194:195], v216 offset:4608
    v_mov_b32 v185, 0
    v_mfma_f32_32x32x16_bf16 v[128:143], v[204:207], v[60:63], v[128:143]
    ds_read_b64_tr_b16 v[196:197], v216 offset:6144
    ds_read_b64_tr_b16 v[198:199], v216 offset:6656
    v_mov_b32 v186, 0
    s_waitcnt lgkmcnt(4)
    v_mfma_f32_32x32x16_bf16 v[128:143], v[208:211], v[64:67], v[128:143]
    ds_read_b64_tr_b16 v[200:201], v216 offset:8192
    ds_read_b64_tr_b16 v[202:203], v216 offset:8704
    v_mov_b32 v187, 0
    v_mfma_f32_32x32x16_bf16 v[128:143], v[212:215], v[68:71], v[128:143]
    ds_read_b64_tr_b16 v[204:205], v216 offset:10240
    ds_read_b64_tr_b16 v[206:207], v216 offset:10752
    s_waitcnt lgkmcnt(4)
    v_mfma_f32_32x32x16_bf16 v[128:143], v[192:195], v[72:75], v[128:143]
    ds_read_b64_tr_b16 v[208:209], v216 offset:12288
    ds_read_b64_tr_b16 v[210:211], v216 offset:12800
    v_mfma_f32_32x32x16_bf16 v[128:143], v[196:199], v[76:79], v[128:143]
    ds_read_b64_tr_b16 v[212:213], v216 offset:14336
    ds_read_b64_tr_b16 v[214:215], v216 offset:14848
    s_waitcnt lgkmcnt(4)
    v_mfma_f32_32x32x16_bf16 v[128:143], v[200:203], v[80:83], v[128:143]
    v_add_u32 v216, -65536, v216
    ds_read_b64_tr_b16 v[192:193], v216 offset:16384
    ds_read_b64_tr_b16 v[194:195], v216 offset:16896
    ds_read_b32 v176, v245 offset:512
    ds_read_b32 v180, v245 offset:1280
    ds_read_b32 v184, v246
    v_mfma_f32_32x32x16_bf16 v[128:143], v[204:207], v[84:87], v[128:143]
    ds_read_b64_tr_b16 v[196:197], v216 offset:18432
    ds_read_b64_tr_b16 v[198:199], v216 offset:18944
    s_waitcnt lgkmcnt(7)
    v_mfma_f32_32x32x16_bf16 v[128:143], v[208:211], v[88:91], v[128:143]
    ds_read_b64_tr_b16 v[200:201], v216 offset:20480
    ds_read_b64_tr_b16 v[202:203], v216 offset:20992
    v_mfma_f32_32x32x16_bf16 v[128:143], v[212:215], v[92:95], v[128:143]
    ds_read_b64_tr_b16 v[204:205], v216 offset:22528
    ds_read_b64_tr_b16 v[206:207], v216 offset:23040
    s_waitcnt lgkmcnt(4)
    v_mfma_f32_32x32x16_bf16 v[128:143], v[192:195], v[96:99], v[128:143]
    ds_read_b64_tr_b16 v[208:209], v216 offset:24576
    ds_read_b64_tr_b16 v[210:211], v216 offset:25088
    v_mfma_f32_32x32x16_bf16 v[128:143], v[196:199], v[100:103], v[128:143]
    ds_read_b64_tr_b16 v[212:213], v216 offset:26624
    ds_read_b64_tr_b16 v[214:215], v216 offset:27136
    s_waitcnt lgkmcnt(4)
    v_mfma_f32_32x32x16_bf16 v[128:143], v[200:203], v[104:107], v[128:143]
    ds_read_b64_tr_b16 v[192:193], v216 offset:28672
    ds_read_b64_tr_b16 v[194:195], v216 offset:29184
    v_mfma_f32_32x32x16_bf16 v[128:143], v[204:207], v[108:111], v[128:143]
    ds_read_b64_tr_b16 v[196:197], v216 offset:30720
    ds_read_b64_tr_b16 v[198:199], v216 offset:31232
    s_waitcnt lgkmcnt(4)
    v_mfma_f32_32x32x16_bf16 v[128:143], v[208:211], v[112:115], v[128:143]
    ds_read_b64_tr_b16 v[200:201], v217 offset:8192
    ds_read_b64_tr_b16 v[202:203], v217 offset:8704
    v_mfma_f32_32x32x16_bf16 v[128:143], v[212:215], v[116:119], v[128:143]
    ds_read_b64_tr_b16 v[204:205], v217 offset:10240
    ds_read_b64_tr_b16 v[206:207], v217 offset:10752
    s_waitcnt lgkmcnt(4)
    v_mfma_f32_32x32x16_bf16 v[128:143], v[192:195], v[120:123], v[128:143]
    ds_read_b64_tr_b16 v[208:209], v217 offset:12288
    ds_read_b64_tr_b16 v[210:211], v217 offset:12800
    v_mfma_f32_32x32x16_bf16 v[128:143], v[196:199], v[124:127], v[128:143]
    v_mfma_f32_32x32x16_bf16 v[128:143], v[176:179], v[184:187], v[128:143]
    ds_read_b64_tr_b16 v[212:213], v217 offset:14336
    ds_read_b64_tr_b16 v[214:215], v217 offset:14848
    s_waitcnt lgkmcnt(4)
    v_mfma_f32_32x32x16_bf16 v[144:159], v[200:203], v[0:3], 0
    ds_read_b64_tr_b16 v[192:193], v217 offset:16384
    ds_read_b64_tr_b16 v[194:195], v217 offset:16896
    v_mfma_f32_32x32x16_bf16 v[144:159], v[204:207], v[4:7], v[144:159]
    ds_read_b64_tr_b16 v[196:197], v217 offset:18432
    ds_read_b64_tr_b16 v[198:199], v217 offset:18944
    s_waitcnt lgkmcnt(4)
    v_mfma_f32_32x32x16_bf16 v[144:159], v[208:211], v[8:11], v[144:159]
    ds_read_b64_tr_b16 v[200:201], v217 offset:20480
    ds_read_b64_tr_b16 v[202:203], v217 offset:20992
    v_mul_f32 v128, v128, v232
    v_exp_f32 v224, v128
    v_mfma_f32_32x32x16_bf16 v[144:159], v[212:215], v[12:15], v[144:159]
    ds_read_b64_tr_b16 v[204:205], v217 offset:22528
    ds_read_b64_tr_b16 v[206:207], v217 offset:23040
    v_fma_f32 v227, v224, 0.5, 1.0
    v_mul_f32 v129, v129, v232
    s_waitcnt lgkmcnt(4)
    v_mfma_f32_32x32x16_bf16 v[144:159], v[192:195], v[16:19], v[144:159]
    v_add_u32 v217, -131072, v217
    ds_read_b64_tr_b16 v[208:209], v217 offset:0
    ds_read_b64_tr_b16 v[210:211], v217 offset:512
    v_exp_f32 v225, v129
    v_fma_f32 v227, v224, v227, 1.0
    v_mfma_f32_32x32x16_bf16 v[144:159], v[196:199], v[20:23], v[144:159]
    ds_read_b64_tr_b16 v[212:213], v217 offset:2048
    ds_read_b64_tr_b16 v[214:215], v217 offset:2560
    v_rcp_f32 v227, v227
    v_fma_f32 v228, v225, 0.5, 1.0
    v_mul_f32 v130, v130, v232
    s_waitcnt lgkmcnt(4)
    v_mfma_f32_32x32x16_bf16 v[144:159], v[200:203], v[24:27], v[144:159]
    ds_read_b64_tr_b16 v[192:193], v217 offset:4096
    ds_read_b64_tr_b16 v[194:195], v217 offset:4608
    v_exp_f32 v226, v130
    v_fma_f32 v228, v225, v228, 1.0
    v_fma_f32 v128, -v128, v227, v128
    v_mfma_f32_32x32x16_bf16 v[144:159], v[204:207], v[28:31], v[144:159]
    ds_read_b64_tr_b16 v[196:197], v217 offset:6144
    ds_read_b64_tr_b16 v[198:199], v217 offset:6656
    v_rcp_f32 v228, v228
    v_fma_f32 v229, v226, 0.5, 1.0
    v_mul_f32 v131, v131, v232
    s_waitcnt lgkmcnt(4)
    v_mfma_f32_32x32x16_bf16 v[144:159], v[208:211], v[32:35], v[144:159]
    ds_read_b64_tr_b16 v[200:201], v217 offset:8192
    ds_read_b64_tr_b16 v[202:203], v217 offset:8704
    v_exp_f32 v224, v131
    v_fma_f32 v229, v226, v229, 1.0
    v_fma_f32 v129, -v129, v228, v129
    v_mfma_f32_32x32x16_bf16 v[144:159], v[212:215], v[36:39], v[144:159]
    ds_read_b64_tr_b16 v[204:205], v217 offset:10240
    ds_read_b64_tr_b16 v[206:207], v217 offset:10752
    v_rcp_f32 v229, v229
    v_fma_f32 v227, v224, 0.5, 1.0
    v_mul_f32 v132, v132, v232
    v_cvt_pk_bf16_f32 v128, v128, v129
    s_waitcnt lgkmcnt(4)
    v_mfma_f32_32x32x16_bf16 v[144:159], v[192:195], v[40:43], v[144:159]
    ds_read_b64_tr_b16 v[208:209], v217 offset:12288
    ds_read_b64_tr_b16 v[210:211], v217 offset:12800
    v_exp_f32 v225, v132
    v_fma_f32 v227, v224, v227, 1.0
    v_fma_f32 v130, -v130, v229, v130
    v_mfma_f32_32x32x16_bf16 v[144:159], v[196:199], v[44:47], v[144:159]
    ds_read_b64_tr_b16 v[212:213], v217 offset:14336
    ds_read_b64_tr_b16 v[214:215], v217 offset:14848
    v_rcp_f32 v227, v227
    v_fma_f32 v228, v225, 0.5, 1.0
    v_mul_f32 v133, v133, v232
    s_waitcnt lgkmcnt(4)
    v_mfma_f32_32x32x16_bf16 v[144:159], v[200:203], v[48:51], v[144:159]
    v_add_u32 v217, 65536, v217
    ds_read_b64_tr_b16 v[192:193], v217 offset:0
    ds_read_b64_tr_b16 v[194:195], v217 offset:512
    v_exp_f32 v226, v133
    v_fma_f32 v228, v225, v228, 1.0
    v_fma_f32 v131, -v131, v227, v131
    v_mfma_f32_32x32x16_bf16 v[144:159], v[204:207], v[52:55], v[144:159]
    ds_read_b64_tr_b16 v[196:197], v217 offset:2048
    ds_read_b64_tr_b16 v[198:199], v217 offset:2560
    v_rcp_f32 v228, v228
    v_fma_f32 v229, v226, 0.5, 1.0
    v_mul_f32 v134, v134, v232
    v_cvt_pk_bf16_f32 v129, v130, v131
    s_waitcnt lgkmcnt(4)
    v_mfma_f32_32x32x16_bf16 v[144:159], v[208:211], v[56:59], v[144:159]
    ds_read_b64_tr_b16 v[200:201], v217 offset:4096
    ds_read_b64_tr_b16 v[202:203], v217 offset:4608
    v_exp_f32 v224, v134
    v_fma_f32 v229, v226, v229, 1.0
    v_fma_f32 v132, -v132, v228, v132
    v_mfma_f32_32x32x16_bf16 v[144:159], v[212:215], v[60:63], v[144:159]
    ds_read_b64_tr_b16 v[204:205], v217 offset:6144
    ds_read_b64_tr_b16 v[206:207], v217 offset:6656
    v_rcp_f32 v229, v229
    v_fma_f32 v227, v224, 0.5, 1.0
    v_mul_f32 v135, v135, v232
    s_waitcnt lgkmcnt(4)
    v_mfma_f32_32x32x16_bf16 v[144:159], v[192:195], v[64:67], v[144:159]
    ds_read_b64_tr_b16 v[208:209], v217 offset:8192
    ds_read_b64_tr_b16 v[210:211], v217 offset:8704
    v_exp_f32 v225, v135
    v_fma_f32 v227, v224, v227, 1.0
    v_fma_f32 v133, -v133, v229, v133
    v_mfma_f32_32x32x16_bf16 v[144:159], v[196:199], v[68:71], v[144:159]
    ds_read_b64_tr_b16 v[212:213], v217 offset:10240
    ds_read_b64_tr_b16 v[214:215], v217 offset:10752
    v_rcp_f32 v227, v227
    v_fma_f32 v228, v225, 0.5, 1.0
    v_mul_f32 v136, v136, v232
    v_cvt_pk_bf16_f32 v130, v132, v133
    s_waitcnt lgkmcnt(4)
    v_mfma_f32_32x32x16_bf16 v[144:159], v[200:203], v[72:75], v[144:159]
    ds_read_b64_tr_b16 v[192:193], v217 offset:12288
    ds_read_b64_tr_b16 v[194:195], v217 offset:12800
    v_exp_f32 v226, v136
    v_fma_f32 v228, v225, v228, 1.0
    v_fma_f32 v134, -v134, v227, v134
    v_mfma_f32_32x32x16_bf16 v[144:159], v[204:207], v[76:79], v[144:159]
    ds_read_b64_tr_b16 v[196:197], v217 offset:14336
    ds_read_b64_tr_b16 v[198:199], v217 offset:14848
    v_rcp_f32 v228, v228
    v_fma_f32 v229, v226, 0.5, 1.0
    v_mul_f32 v137, v137, v232
    s_waitcnt lgkmcnt(4)
    v_mfma_f32_32x32x16_bf16 v[144:159], v[208:211], v[80:83], v[144:159]
    v_add_u32 v217, -65536, v217
    ds_read_b64_tr_b16 v[200:201], v217 offset:16384
    ds_read_b64_tr_b16 v[202:203], v217 offset:16896
    v_exp_f32 v224, v137
    v_fma_f32 v229, v226, v229, 1.0
    v_fma_f32 v135, -v135, v228, v135
    v_mfma_f32_32x32x16_bf16 v[144:159], v[212:215], v[84:87], v[144:159]
    ds_read_b64_tr_b16 v[204:205], v217 offset:18432
    ds_read_b64_tr_b16 v[206:207], v217 offset:18944
    v_rcp_f32 v229, v229
    v_fma_f32 v227, v224, 0.5, 1.0
    v_mul_f32 v138, v138, v232
    v_cvt_pk_bf16_f32 v131, v134, v135
    buffer_store_dwordx4 v[128:131], v254, s[56:59], s82 offen offset:0 sc1
    s_waitcnt lgkmcnt(4)
    v_mfma_f32_32x32x16_bf16 v[144:159], v[192:195], v[88:91], v[144:159]
    ds_read_b64_tr_b16 v[208:209], v217 offset:20480
    ds_read_b64_tr_b16 v[210:211], v217 offset:20992
    v_exp_f32 v225, v138
    v_fma_f32 v227, v224, v227, 1.0
    v_fma_f32 v136, -v136, v229, v136
    v_mfma_f32_32x32x16_bf16 v[144:159], v[196:199], v[92:95], v[144:159]
    ds_read_b64_tr_b16 v[212:213], v217 offset:22528
    ds_read_b64_tr_b16 v[214:215], v217 offset:23040
    v_rcp_f32 v227, v227
    v_fma_f32 v228, v225, 0.5, 1.0
    v_mul_f32 v139, v139, v232
    s_waitcnt lgkmcnt(4)
    v_mfma_f32_32x32x16_bf16 v[144:159], v[200:203], v[96:99], v[144:159]
    ds_read_b64_tr_b16 v[192:193], v217 offset:24576
    ds_read_b64_tr_b16 v[194:195], v217 offset:25088
    v_exp_f32 v226, v139
    v_fma_f32 v228, v225, v228, 1.0
    v_fma_f32 v137, -v137, v227, v137
    v_mfma_f32_32x32x16_bf16 v[144:159], v[204:207], v[100:103], v[144:159]
    ds_read_b64_tr_b16 v[196:197], v217 offset:26624
    ds_read_b64_tr_b16 v[198:199], v217 offset:27136
    v_rcp_f32 v228, v228
    v_fma_f32 v229, v226, 0.5, 1.0
    v_mul_f32 v140, v140, v232
    v_cvt_pk_bf16_f32 v132, v136, v137
    s_waitcnt lgkmcnt(4)
    v_mfma_f32_32x32x16_bf16 v[144:159], v[208:211], v[104:107], v[144:159]
    ds_read_b64_tr_b16 v[200:201], v217 offset:28672
    ds_read_b64_tr_b16 v[202:203], v217 offset:29184
    v_exp_f32 v224, v140
    v_fma_f32 v229, v226, v229, 1.0
    v_fma_f32 v138, -v138, v228, v138
    v_mfma_f32_32x32x16_bf16 v[144:159], v[212:215], v[108:111], v[144:159]
    ds_read_b64_tr_b16 v[204:205], v217 offset:30720
    ds_read_b64_tr_b16 v[206:207], v217 offset:31232
    v_rcp_f32 v229, v229
    v_fma_f32 v227, v224, 0.5, 1.0
    v_mul_f32 v141, v141, v232
    s_waitcnt lgkmcnt(4)
    v_mfma_f32_32x32x16_bf16 v[144:159], v[192:195], v[112:115], v[144:159]
    v_exp_f32 v225, v141
    v_fma_f32 v227, v224, v227, 1.0
    v_fma_f32 v139, -v139, v229, v139
    v_mfma_f32_32x32x16_bf16 v[144:159], v[196:199], v[116:119], v[144:159]
    v_rcp_f32 v227, v227
    v_fma_f32 v228, v225, 0.5, 1.0
    v_mul_f32 v142, v142, v232
    v_cvt_pk_bf16_f32 v133, v138, v139
    s_waitcnt lgkmcnt(0)
    v_mfma_f32_32x32x16_bf16 v[144:159], v[200:203], v[120:123], v[144:159]
    v_exp_f32 v226, v142
    v_fma_f32 v228, v225, v228, 1.0
    v_fma_f32 v140, -v140, v227, v140
    v_mfma_f32_32x32x16_bf16 v[144:159], v[204:207], v[124:127], v[144:159]
    v_rcp_f32 v228, v228
    v_fma_f32 v229, v226, 0.5, 1.0
    v_mul_f32 v143, v143, v232
    s_lshl_b32 s14, s84, 2
    s_add_u32 s14, s14, 134944
    v_mov_b32 v216, s14
    v_mov_b32 v217, 2
    ds_write_b32 v216, v217
    v_mfma_f32_32x32x16_bf16 v[144:159], v[180:183], v[184:187], v[144:159]
    v_exp_f32 v224, v143
    v_fma_f32 v229, v226, v229, 1.0
    v_fma_f32 v141, -v141, v228, v141
    v_rcp_f32 v229, v229
    v_fma_f32 v227, v224, 0.5, 1.0
    v_cvt_pk_bf16_f32 v134, v140, v141
    v_fma_f32 v227, v224, v227, 1.0
    v_fma_f32 v142, -v142, v229, v142
    v_rcp_f32 v227, v227
    s_nop 0
    v_fma_f32 v143, -v143, v227, v143
    v_cvt_pk_bf16_f32 v135, v142, v143
    buffer_store_dwordx4 v[132:135], v254, s[56:59], s82 offen offset:2048 sc1
    s_setprio 1
    v_mul_f32 v144, v144, v232
    v_mul_f32 v145, v145, v232
    v_mul_f32 v146, v146, v232
    v_mul_f32 v147, v147, v232
    v_mul_f32 v148, v148, v232
    v_mul_f32 v149, v149, v232
    v_mul_f32 v150, v150, v232
    v_mul_f32 v151, v151, v232
    v_mul_f32 v152, v152, v232
    v_mul_f32 v153, v153, v232
    v_mul_f32 v154, v154, v232
    v_mul_f32 v155, v155, v232
    v_mul_f32 v156, v156, v232
    v_mul_f32 v157, v157, v232
    v_mul_f32 v158, v158, v232
    v_mul_f32 v159, v159, v232
    v_exp_f32 v16, v144
    v_exp_f32 v17, v145
    v_exp_f32 v18, v146
    v_exp_f32 v19, v147
    v_exp_f32 v20, v148
    v_exp_f32 v21, v149
    v_exp_f32 v22, v150
    v_exp_f32 v23, v151
    v_exp_f32 v24, v152
    v_exp_f32 v25, v153
    v_exp_f32 v26, v154
    v_exp_f32 v27, v155
    v_exp_f32 v28, v156
    v_exp_f32 v29, v157
    v_exp_f32 v30, v158
    v_exp_f32 v31, v159
    v_fma_f32 v32, v16, 0.5, 1.0
    v_fma_f32 v33, v17, 0.5, 1.0
    v_fma_f32 v34, v18, 0.5, 1.0
    v_fma_f32 v35, v19, 0.5, 1.0
    v_fma_f32 v36, v20, 0.5, 1.0
    v_fma_f32 v37, v21, 0.5, 1.0
    v_fma_f32 v38, v22, 0.5, 1.0
    v_fma_f32 v39, v23, 0.5, 1.0
    v_fma_f32 v40, v24, 0.5, 1.0
    v_fma_f32 v41, v25, 0.5, 1.0
    v_fma_f32 v42, v26, 0.5, 1.0
    v_fma_f32 v43, v27, 0.5, 1.0
    v_fma_f32 v44, v28, 0.5, 1.0
    v_fma_f32 v45, v29, 0.5, 1.0
    v_fma_f32 v46, v30, 0.5, 1.0
    v_fma_f32 v47, v31, 0.5, 1.0
    v_fma_f32 v32, v16, v32, 1.0
    v_fma_f32 v33, v17, v33, 1.0
    v_fma_f32 v34, v18, v34, 1.0
    v_fma_f32 v35, v19, v35, 1.0
    v_fma_f32 v36, v20, v36, 1.0
    v_fma_f32 v37, v21, v37, 1.0
    v_fma_f32 v38, v22, v38, 1.0
    v_fma_f32 v39, v23, v39, 1.0
    v_fma_f32 v40, v24, v40, 1.0
    v_fma_f32 v41, v25, v41, 1.0
    v_fma_f32 v42, v26, v42, 1.0
    v_fma_f32 v43, v27, v43, 1.0
    v_fma_f32 v44, v28, v44, 1.0
    v_fma_f32 v45, v29, v45, 1.0
    v_fma_f32 v46, v30, v46, 1.0
    v_fma_f32 v47, v31, v47, 1.0
    v_rcp_f32 v32, v32
    v_rcp_f32 v33, v33
    v_rcp_f32 v34, v34
    v_rcp_f32 v35, v35
    v_rcp_f32 v36, v36
    v_rcp_f32 v37, v37
    v_rcp_f32 v38, v38
    v_rcp_f32 v39, v39
    v_rcp_f32 v40, v40
    v_rcp_f32 v41, v41
    v_rcp_f32 v42, v42
    v_rcp_f32 v43, v43
    v_rcp_f32 v44, v44
    v_rcp_f32 v45, v45
    v_rcp_f32 v46, v46
    v_rcp_f32 v47, v47
    v_fma_f32 v144, -v144, v32, v144
    v_fma_f32 v145, -v145, v33, v145
    v_fma_f32 v146, -v146, v34, v146
    v_fma_f32 v147, -v147, v35, v147
    v_fma_f32 v148, -v148, v36, v148
    v_fma_f32 v149, -v149, v37, v149
    v_fma_f32 v150, -v150, v38, v150
    v_fma_f32 v151, -v151, v39, v151
    v_fma_f32 v152, -v152, v40, v152
    v_fma_f32 v153, -v153, v41, v153
    v_fma_f32 v154, -v154, v42, v154
    v_fma_f32 v155, -v155, v43, v155
    v_fma_f32 v156, -v156, v44, v156
    v_fma_f32 v157, -v157, v45, v157
    v_fma_f32 v158, -v158, v46, v158
    v_fma_f32 v159, -v159, v47, v159
    v_cvt_pk_bf16_f32 v144, v144, v145
    v_cvt_pk_bf16_f32 v145, v146, v147
    v_cvt_pk_bf16_f32 v146, v148, v149
    v_cvt_pk_bf16_f32 v147, v150, v151
    v_cvt_pk_bf16_f32 v148, v152, v153
    v_cvt_pk_bf16_f32 v149, v154, v155
    v_cvt_pk_bf16_f32 v150, v156, v157
    v_cvt_pk_bf16_f32 v151, v158, v159
    buffer_store_dwordx4 v[144:147], v254, s[56:59], s81 offen sc1
    buffer_store_dwordx4 v[148:151], v254, s[56:59], s81 offen offset:2048 sc1
    s_waitcnt vmcnt(0)
    buffer_store_dword v252, v242, s[56:59], s83 offen offset:32 sc1
    s_branch C_P2
CX_NOH:
    ds_write_b32 v248, v248
    s_lshl_b32 s14, s84, 2
    s_add_u32 s14, s14, 134944
    v_mov_b32 v224, s14
    v_mov_b32 v225, 2
    ds_write_b32 v224, v225
    s_nop 1
C_P2:
    s_setprio 0
    v_lshlrev_b32 v236, 2, v255
    v_and_b32 v236, 0x7c, v236
    s_lshl_b32 s78, s12, 3
    s_add_u32 s78, s78, s4
    s_lshl_b32 s78, s78, 7
    s_add_u32 s78, s78, 0xc90000
    v_lshrrev_b32 v240, 3, v255
    v_and_b32 v241, 7, v255
    v_lshlrev_b32 v240, 10, v240
    v_lshl_add_u32 v240, v241, 4, v240
    s_lshl_b32 s6, s12, 3
    s_add_u32 s6, s6, s4
    s_lshl_b32 s6, s6, 13
    s_lshl_b32 s7, s13, 7
    s_add_u32 s6, s6, s7
    buffer_load_dwordx4 v[244:247], v240, s[40:43], s6 offen
    buffer_load_dword v237, v236, s[56:59], s78 offen sc1
    s_mul_i32 s79, s12, 245760
    s_lshl_b32 s14, s87, 5
    s_add_u32 s14, s14, s86
    s_lshl_b32 s14, s14, 10
    s_add_u32 s79, s79, s14
    s_add_u32 s79, s79, 180224
    v_lshrrev_b32 v248, 5, v255
    v_bfe_u32 v249, v255, 2, 2
    v_mul_u32_u24 v248, 4, v248
    v_add_lshl_u32 v232, v248, v249, 7
    v_bfe_u32 v248, v255, 3, 1
    v_lshl_add_u32 v232, v248, 6, v232
    v_bfe_u32 v248, v255, 4, 1
    v_lshl_add_u32 v232, v248, 5, v232
    v_and_b32 v248, 3, v255
    v_lshl_add_u32 v232, v248, 3, v232
    s_lshl_b32 s76, s87, 13
    s_add_u32 s76, s76, 32768
    v_add_u32 v232, s76, v232
    v_xor_b32 v233, 64, v232
    v_add_u32 v234, 65536, v232
    v_add_u32 v235, 65536, v233
    s_lshl_b32 s76, s84, 12
    s_add_u32 s76, s76, 32768
    v_and_b32 v224, 31, v255
    v_lshrrev_b32 v225, 5, v255
    v_xor_b32 v225, v225, v255
    v_and_b32 v225, 7, v225
    v_lshlrev_b32 v225, 4, v225
    v_lshl_add_u32 v224, v224, 7, v225
    v_add_u32 v224, s76, v224
    v_xor_b32 v225, 32, v224
    v_xor_b32 v226, 64, v224
    v_xor_b32 v227, 96, v224
    v_xor_b32 v228, 16, v224
    v_add_u32 v228, 65536, v228
    v_xor_b32 v229, 16, v225
    v_add_u32 v229, 65536, v229
    v_xor_b32 v230, 16, v226
    v_add_u32 v230, 65536, v230
    v_xor_b32 v231, 16, v227
    v_add_u32 v231, 65536, v231
    v_mov_b32 v238, 134928
    s_lshl_b32 s76, s84, 2
    s_add_u32 s76, s76, 135008
    v_mov_b32 v239, s76
    s_mov_b32 s14, 0
    s_nop 1
CWO_P:
    ds_read_b128 v[248:251], v238
    s_add_u32 s14, s14, 1
    s_waitcnt lgkmcnt(0)
    v_min3_u32 v248, v248, v249, v250
    v_min_u32 v248, v248, v251
    s_nop 0
    v_readfirstlane_b32 s15, v248
    s_cmp_gt_u32 s14, 0x80000
    s_nop 0
    s_cselect_b32 s15, 3, s15
    s_cmp_lt_u32 s15, 3
    s_nop 0
    s_cbranch_scc1 CWO_P
    ds_read_b64_tr_b16 v[96:97], v232 offset:0
    ds_read_b64_tr_b16 v[98:99], v232 offset:1024
    ds_read_b64_tr_b16 v[100:101], v233 offset:0
    ds_read_b64_tr_b16 v[102:103], v233 offset:1024
    ds_read_b64_tr_b16 v[104:105], v232 offset:2048
    ds_read_b64_tr_b16 v[106:107], v232 offset:3072
    ds_read_b64_tr_b16 v[108:109], v233 offset:2048
    ds_read_b64_tr_b16 v[110:111], v233 offset:3072
    ds_read_b64_tr_b16 v[112:113], v232 offset:16384
    ds_read_b64_tr_b16 v[114:115], v232 offset:17408
    ds_read_b64_tr_b16 v[116:117], v233 offset:16384
    ds_read_b64_tr_b16 v[118:119], v233 offset:17408
    ds_read_b64_tr_b16 v[120:121], v232 offset:18432
    ds_read_b64_tr_b16 v[122:123], v232 offset:19456
    ds_read_b64_tr_b16 v[124:125], v233 offset:18432
    ds_read_b64_tr_b16 v[126:127], v233 offset:19456
    ds_read_b64_tr_b16 v[128:129], v234 offset:0
    ds_read_b64_tr_b16 v[130:131], v234 offset:1024
    ds_read_b64_tr_b16 v[132:133], v235 offset:0
    ds_read_b64_tr_b16 v[134:135], v235 offset:1024
    ds_read_b64_tr_b16 v[136:137], v234 offset:2048
    ds_read_b64_tr_b16 v[138:139], v234 offset:3072
    ds_read_b64_tr_b16 v[140:141], v235 offset:2048
    ds_read_b64_tr_b16 v[142:143], v235 offset:3072
    ds_read_b64_tr_b16 v[144:145], v234 offset:16384
    ds_read_b64_tr_b16 v[146:147], v234 offset:17408
    ds_read_b64_tr_b16 v[148:149], v235 offset:16384
    ds_read_b64_tr_b16 v[150:151], v235 offset:17408
    ds_read_b64_tr_b16 v[152:153], v234 offset:18432
    ds_read_b64_tr_b16 v[154:155], v234 offset:19456
    ds_read_b64_tr_b16 v[156:157], v235 offset:18432
    ds_read_b64_tr_b16 v[158:159], v235 offset:19456
    ds_read_b64_tr_b16 v[160:161], v232 offset:4096
    ds_read_b64_tr_b16 v[162:163], v232 offset:5120
    ds_read_b64_tr_b16 v[164:165], v233 offset:4096
    ds_read_b64_tr_b16 v[166:167], v233 offset:5120
    ds_read_b64_tr_b16 v[168:169], v232 offset:6144
    ds_read_b64_tr_b16 v[170:171], v232 offset:7168
    ds_read_b64_tr_b16 v[172:173], v233 offset:6144
    ds_read_b64_tr_b16 v[174:175], v233 offset:7168
    ds_read_b64_tr_b16 v[176:177], v232 offset:20480
    ds_read_b64_tr_b16 v[178:179], v232 offset:21504
    ds_read_b64_tr_b16 v[180:181], v233 offset:20480
    ds_read_b64_tr_b16 v[182:183], v233 offset:21504
    ds_read_b64_tr_b16 v[184:185], v232 offset:22528
    ds_read_b64_tr_b16 v[186:187], v232 offset:23552
    ds_read_b64_tr_b16 v[188:189], v233 offset:22528
    ds_read_b64_tr_b16 v[190:191], v233 offset:23552
    ds_read_b64_tr_b16 v[192:193], v234 offset:4096
    ds_read_b64_tr_b16 v[194:195], v234 offset:5120
    ds_read_b64_tr_b16 v[196:197], v235 offset:4096
    ds_read_b64_tr_b16 v[198:199], v235 offset:5120
    ds_read_b64_tr_b16 v[200:201], v234 offset:6144
    ds_read_b64_tr_b16 v[202:203], v234 offset:7168
    ds_read_b64_tr_b16 v[204:205], v235 offset:6144
    ds_read_b64_tr_b16 v[206:207], v235 offset:7168
    ds_read_b64_tr_b16 v[208:209], v234 offset:20480
    ds_read_b64_tr_b16 v[210:211], v234 offset:21504
    ds_read_b64_tr_b16 v[212:213], v235 offset:20480
    ds_read_b64_tr_b16 v[214:215], v235 offset:21504
    ds_read_b64_tr_b16 v[216:217], v234 offset:22528
    ds_read_b64_tr_b16 v[218:219], v234 offset:23552
    ds_read_b64_tr_b16 v[220:221], v235 offset:22528
    ds_read_b64_tr_b16 v[222:223], v235 offset:23552
    ds_write_b32 v239, v239
    v_xor_b32 v238, 4, v239
    s_waitcnt vmcnt(0)
    s_mov_b32 s14, 0
    s_nop 0
CQ_P:
    v_cmp_ne_u32 vcc, s3, v237
    s_nop 1
    s_and_b32 vcc_lo, vcc_lo, 0xf
    s_cmp_eq_u32 vcc_lo, 0
    s_nop 0
    s_cbranch_scc1 CQ_G
    s_add_u32 s14, s14, 1
    s_cmp_gt_u32 s14, 0x8000
    s_cbranch_scc1 CQ_G
    s_sleep 8
    buffer_load_dword v237, v236, s[56:59], s78 offen sc1
    s_waitcnt vmcnt(0)
    s_branch CQ_P
CQ_G:
    buffer_load_dwordx4 v[32:35], v254, s[56:59], s79 offen offset:0 sc1
    buffer_load_dwordx4 v[36:39], v254, s[56:59], s79 offen offset:2048 sc1
    s_add_u32 s79, s79, 4096
    buffer_load_dwordx4 v[40:43], v254, s[56:59], s79 offen offset:0 sc1
    buffer_load_dwordx4 v[44:47], v254, s[56:59], s79 offen offset:2048 sc1
    s_add_u32 s79, s79, 4096
    buffer_load_dwordx4 v[48:51], v254, s[56:59], s79 offen offset:0 sc1
    buffer_load_dwordx4 v[52:55], v254, s[56:59], s79 offen offset:2048 sc1
    s_add_u32 s79, s79, 4096
    buffer_load_dwordx4 v[56:59], v254, s[56:59], s79 offen offset:0 sc1
    buffer_load_dwordx4 v[60:63], v254, s[56:59], s79 offen offset:2048 sc1
    s_mov_b32 s14, 0
CWR_P:
    ds_read_b32 v248, v238
    s_add_u32 s14, s14, 1
    s_waitcnt lgkmcnt(0)
    v_readfirstlane_b32 s15, v248
    s_cmp_gt_u32 s14, 0x80000
    s_nop 0
    s_cselect_b32 s15, 1, s15
    s_cmp_lt_u32 s15, 1
    s_nop 0
    s_cbranch_scc1 CWR_P
    s_waitcnt vmcnt(7)
    v_mfma_f32_32x32x16_bf16 v[0:15], v[96:99], v[32:35], 0
    v_mfma_f32_32x32x16_bf16 v[16:31], v[100:103], v[32:35], 0
    s_add_u32 s79, s79, 4096
    buffer_load_dwordx4 v[64:67], v254, s[56:59], s79 offen offset:0 sc1
    s_waitcnt vmcnt(7)
    v_mfma_f32_32x32x16_bf16 v[0:15], v[104:107], v[36:39], v[0:15]
    v_mfma_f32_32x32x16_bf16 v[16:31], v[108:111], v[36:39], v[16:31]
    buffer_load_dwordx4 v[68:71], v254, s[56:59], s79 offen offset:2048 sc1
    s_waitcnt vmcnt(7)
    v_mfma_f32_32x32x16_bf16 v[0:15], v[112:115], v[40:43], v[0:15]
    v_mfma_f32_32x32x16_bf16 v[16:31], v[116:119], v[40:43], v[16:31]
    s_add_u32 s79, s79, 4096
    buffer_load_dwordx4 v[72:75], v254, s[56:59], s79 offen offset:0 sc1
    s_waitcnt vmcnt(7)
    v_mfma_f32_32x32x16_bf16 v[0:15], v[120:123], v[44:47], v[0:15]
    v_mfma_f32_32x32x16_bf16 v[16:31], v[124:127], v[44:47], v[16:31]
    buffer_load_dwordx4 v[76:79], v254, s[56:59], s79 offen offset:2048 sc1
    s_waitcnt vmcnt(7)
    v_mfma_f32_32x32x16_bf16 v[0:15], v[128:131], v[48:51], v[0:15]
    v_mfma_f32_32x32x16_bf16 v[16:31], v[132:135], v[48:51], v[16:31]
    s_add_u32 s79, s79, 4096
    buffer_load_dwordx4 v[80:83], v254, s[56:59], s79 offen offset:0 sc1
    s_waitcnt vmcnt(7)
    v_mfma_f32_32x32x16_bf16 v[0:15], v[136:139], v[52:55], v[0:15]
    v_mfma_f32_32x32x16_bf16 v[16:31], v[140:143], v[52:55], v[16:31]
    buffer_load_dwordx4 v[84:87], v254, s[56:59], s79 offen offset:2048 sc1
    s_waitcnt vmcnt(7)
    v_mfma_f32_32x32x16_bf16 v[0:15], v[144:147], v[56:59], v[0:15]
    v_mfma_f32_32x32x16_bf16 v[16:31], v[148:151], v[56:59], v[16:31]
    s_add_u32 s79, s79, 4096
    buffer_load_dwordx4 v[88:91], v254, s[56:59], s79 offen offset:0 sc1
    s_waitcnt vmcnt(7)
    v_mfma_f32_32x32x16_bf16 v[0:15], v[152:155], v[60:63], v[0:15]
    v_mfma_f32_32x32x16_bf16 v[16:31], v[156:159], v[60:63], v[16:31]
    buffer_load_dwordx4 v[92:95], v254, s[56:59], s79 offen offset:2048 sc1
    s_waitcnt vmcnt(7)
    v_mfma_f32_32x32x16_bf16 v[0:15], v[160:163], v[64:67], v[0:15]
    v_mfma_f32_32x32x16_bf16 v[16:31], v[164:167], v[64:67], v[16:31]
    s_waitcnt vmcnt(6)
    v_mfma_f32_32x32x16_bf16 v[0:15], v[168:171], v[68:71], v[0:15]
    v_mfma_f32_32x32x16_bf16 v[16:31], v[172:175], v[68:71], v[16:31]
    s_waitcnt vmcnt(5)
    v_mfma_f32_32x32x16_bf16 v[0:15], v[176:179], v[72:75], v[0:15]
    v_mfma_f32_32x32x16_bf16 v[16:31], v[180:183], v[72:75], v[16:31]
    s_waitcnt vmcnt(4)
    v_mfma_f32_32x32x16_bf16 v[0:15], v[184:187], v[76:79], v[0:15]
    v_mfma_f32_32x32x16_bf16 v[16:31], v[188:191], v[76:79], v[16:31]
    s_waitcnt vmcnt(3)
    v_mfma_f32_32x32x16_bf16 v[0:15], v[192:195], v[80:83], v[0:15]
    v_mfma_f32_32x32x16_bf16 v[16:31], v[196:199], v[80:83], v[16:31]
    s_waitcnt vmcnt(2)
    v_mfma_f32_32x32x16_bf16 v[0:15], v[200:203], v[84:87], v[0:15]
    v_mfma_f32_32x32x16_bf16 v[16:31], v[204:207], v[84:87], v[16:31]
    s_waitcnt vmcnt(1)
    v_mfma_f32_32x32x16_bf16 v[0:15], v[208:211], v[88:91], v[0:15]
    v_mfma_f32_32x32x16_bf16 v[16:31], v[212:215], v[88:91], v[16:31]
    s_waitcnt vmcnt(0)
    v_mfma_f32_32x32x16_bf16 v[0:15], v[216:219], v[92:95], v[0:15]
    v_mfma_f32_32x32x16_bf16 v[16:31], v[220:223], v[92:95], v[16:31]
    s_nop 10
    ds_write_b128 v224, v[0:3] offset:0
    ds_write_b128 v225, v[4:7] offset:0
    ds_write_b128 v226, v[8:11] offset:0
    ds_write_b128 v227, v[12:15] offset:0
    ds_write_b128 v228, v[16:19] offset:0
    ds_write_b128 v229, v[20:23] offset:0
    ds_write_b128 v230, v[24:27] offset:0
    ds_write_b128 v231, v[28:31] offset:0
F_START:
    s_mov_b32 s44, s32
    s_mov_b32 s45, s33
    s_mov_b32 s46, 0x200000
    s_mov_b32 s47, 0x20000
    s_mov_b32 s78, 0x3f317218
    s_mov_b32 s79, 0x3f317218
    s_and_b32 s14, s4, 3
    s_lshl_b32 s14, s14, 10
    s_lshr_b32 s15, s4, 2
    s_lshl_b32 s15, s15, 14
    s_add_u32 s14, s14, s15
    v_lshrrev_b32 v72, 3, v255
    v_bfe_u32 v73, v255, 2, 1
    v_and_b32 v74, 3, v255
    v_lshlrev_b32 v74, 1, v74
    v_xor_b32 v74, v74, v72
    v_xor_b32 v74, v74, v73
    v_lshlrev_b32 v74, 4, v74
    v_lshl_add_u32 v74, v72, 7, v74
    v_add_u32 v74, s14, v74
    v_lshl_add_u32 v75, v73, 16, v74
    v_xor_b32 v76, 16, v75
    s_mul_i32 s15, s15, 3
    s_lshr_b32 s15, s15, 2
    v_subrev_u32 v77, s15, v75
    v_subrev_u32 v78, s15, v76
    s_waitcnt vmcnt(0)
    v_lshlrev_b32 v80, 16, v244
    v_and_b32 v81, 0xffff0000, v244
    v_lshlrev_b32 v82, 16, v245
    v_and_b32 v83, 0xffff0000, v245
    v_lshlrev_b32 v84, 16, v246
    v_and_b32 v85, 0xffff0000, v246
    v_lshlrev_b32 v86, 16, v247
    v_and_b32 v87, 0xffff0000, v247
    s_waitcnt lgkmcnt(0)
    s_barrier
    ds_read_b128 v[96:99], v75 offset:0
    ds_read_b128 v[100:103], v76 offset:0
    ds_read_b128 v[104:107], v75 offset:4096
    ds_read_b128 v[108:111], v76 offset:4096
    ds_read_b128 v[112:115], v75 offset:8192
    ds_read_b128 v[116:119], v76 offset:8192
    ds_read_b128 v[120:123], v75 offset:12288
    ds_read_b128 v[124:127], v76 offset:12288
    ds_read_b128 v[128:131], v77 offset:32768
    ds_read_b128 v[132:135], v78 offset:32768
    ds_read_b128 v[136:139], v77 offset:40960
    ds_read_b128 v[140:143], v78 offset:40960
    s_waitcnt lgkmcnt(8)
    v_pk_add_f32 v[96:97], v[96:97], v[104:105]
    v_pk_add_f32 v[98:99], v[98:99], v[106:107]
    v_pk_add_f32 v[100:101], v[100:101], v[108:109]
    v_pk_add_f32 v[102:103], v[102:103], v[110:111]
    v_pk_fma_f32 v[80:81], v[96:97], s[78:79], v[80:81]
    v_pk_fma_f32 v[82:83], v[98:99], s[78:79], v[82:83]
    v_pk_fma_f32 v[84:85], v[100:101], s[78:79], v[84:85]
    v_pk_fma_f32 v[86:87], v[102:103], s[78:79], v[86:87]
    s_waitcnt lgkmcnt(4)
    v_pk_add_f32 v[112:113], v[112:113], v[120:121]
    v_pk_add_f32 v[114:115], v[114:115], v[122:123]
    v_pk_add_f32 v[116:117], v[116:117], v[124:125]
    v_pk_add_f32 v[118:119], v[118:119], v[126:127]
    v_pk_fma_f32 v[80:81], v[112:113], s[78:79], v[80:81]
    v_pk_fma_f32 v[82:83], v[114:115], s[78:79], v[82:83]
    v_pk_fma_f32 v[84:85], v[116:117], s[78:79], v[84:85]
    v_pk_fma_f32 v[86:87], v[118:119], s[78:79], v[86:87]
    s_waitcnt lgkmcnt(0)
    v_pk_add_f32 v[128:129], v[128:129], v[136:137]
    v_pk_add_f32 v[130:131], v[130:131], v[138:139]
    v_pk_add_f32 v[132:133], v[132:133], v[140:141]
    v_pk_add_f32 v[134:135], v[134:135], v[142:143]
    v_pk_add_f32 v[80:81], v[80:81], v[128:129]
    v_pk_add_f32 v[82:83], v[82:83], v[130:131]
    v_pk_add_f32 v[84:85], v[84:85], v[132:133]
    v_pk_add_f32 v[86:87], v[86:87], v[134:135]
    v_cvt_pk_bf16_f32 v80, v80, v81
    v_cvt_pk_bf16_f32 v81, v82, v83
    v_cvt_pk_bf16_f32 v82, v84, v85
    v_cvt_pk_bf16_f32 v83, v86, v87
    buffer_store_dwordx4 v[80:83], v240, s[44:47], s6 offen sc1
    s_nop 1
L_END:
    s_endpgm
VK_R:
    s_add_u32 s38, s38, 1
    s_cmp_gt_u32 s38, 0x8000
    s_cbranch_scc1 VK_K
    s_sleep 2
    s_nop 7
    s_nop 7
    buffer_load_dwordx4 v[176:179], v196, s[56:59], s7 offen sc1
    buffer_load_dwordx4 v[0:3], v254, s[56:59], s79 offen offset:0 sc1
    buffer_load_dwordx4 v[4:7], v254, s[56:59], s80 offen offset:0 sc1
    buffer_load_dwordx4 v[8:11], v254, s[56:59], s79 offen offset:1024 sc1
    buffer_load_dwordx4 v[12:15], v254, s[56:59], s80 offen offset:1024 sc1
    buffer_load_dwordx4 v[16:19], v254, s[56:59], s79 offen offset:2048 sc1
    buffer_load_dwordx4 v[20:23], v254, s[56:59], s80 offen offset:2048 sc1
    buffer_load_dwordx4 v[24:27], v254, s[56:59], s79 offen offset:3072 sc1
    buffer_load_dwordx4 v[28:31], v254, s[56:59], s80 offen offset:3072 sc1
    buffer_load_dwordx4 v[32:35], v254, s[56:59], s81 offen offset:0 sc1
    buffer_load_dwordx4 v[36:39], v254, s[56:59], s6 offen offset:0 sc1
    buffer_load_dwordx4 v[40:43], v254, s[56:59], s81 offen offset:1024 sc1
    buffer_load_dwordx4 v[44:47], v254, s[56:59], s6 offen offset:1024 sc1
    buffer_load_dwordx4 v[48:51], v254, s[56:59], s81 offen offset:2048 sc1
    buffer_load_dwordx4 v[52:55], v254, s[56:59], s6 offen offset:2048 sc1
    buffer_load_dwordx4 v[56:59], v254, s[56:59], s81 offen offset:3072 sc1
    buffer_load_dwordx4 v[60:63], v254, s[56:59], s6 offen offset:3072 sc1
    s_waitcnt vmcnt(0)
    s_branch VK_B

.section .rodata,"a"
.p2align 6
.amdhsa_kernel parallel_sum__linear_kernel_hedgehog__dense_activation_mish__prompt_kernel
  .amdhsa_next_free_vgpr 256
  .amdhsa_next_free_sgpr 102
  .amdhsa_accum_offset 256
  .amdhsa_group_segment_fixed_size 0
  .amdhsa_kernarg_size 88
  .amdhsa_user_sgpr_count 2
  .amdhsa_user_sgpr_kernarg_segment_ptr 1
  .amdhsa_system_sgpr_workgroup_id_x 1
.end_amdhsa_kernel
```
